```python
import torch

def _softmax(x, axis=-1):
    return torch.softmax(x, dim=axis)
def _gelu(x):
    return torch.nn.functional.gelu(x, approximate="tanh")
def _silu(x):
    return torch.nn.functional.silu(x)
def _sigmoid(x):
    return torch.sigmoid(x)
def _layernorm(x, axis=-1, eps=1e-5):
    m = x.mean(dim=axis, keepdim=True)
    v = x.var(dim=axis, keepdim=True, unbiased=False)
    return (x - m) / torch.sqrt(v + eps)
def _scatter_add(tgt, idx, src, axis=0):
    return tgt.clone().index_add_(axis, idx, src)
def _segment_sum(src, seg, n):
    out = torch.zeros((n,) + src.shape[1:], dtype=src.dtype)
    return out.index_add_(0, seg, src)
def _pad(x, pw):
    flat = tuple(v for pair in reversed(pw) for v in pair)
    return torch.nn.functional.pad(x, flat)

kernel_name = 'standalone__gqa_softmax__near_ridge'

def setup_inputs():

    _w = (lambda a: (lambda t: t.to(torch.bfloat16) if t.is_floating_point() else t)(torch.as_tensor(a)))
    B, Hq, Hkv, Sq, Sk, D = 8, 32, 8, 96, 2048, 128
    return {
        "q": _w((lambda *s: torch.randn(*s, dtype=torch.bfloat16) * 0.8)(B, Hq, Sq, D)),
        "k": _w((lambda *s: torch.randn(*s, dtype=torch.bfloat16) * 0.8)(B, Hkv, Sk, D)),
        "v": _w((lambda *s: torch.randn(*s, dtype=torch.bfloat16) * 0.05)(B, Hkv, Sk, D)),
    }

def reference(q, k, v):
    B, Hq, Sq, D = q.shape
    Hkv = k.shape[1]
    rep = Hq // Hkv
    k = (lambda x, n, axis: torch.repeat_interleave(x, n, dim=axis))(k, rep, axis=1)
    v = (lambda x, n, axis: torch.repeat_interleave(x, n, dim=axis))(v, rep, axis=1)
    scale = D ** -0.5
    scores = torch.einsum("bhqd,bhkd->bhqk", q, k) * scale
    p = _softmax(scores, axis=-1)
    return torch.einsum("bhqk,bhkd->bhqd", p, v)
```

```asm
; @launch grid=(256,1,1) block=(256,1,1) lds=163840
.amdgcn_target "amdgcn-amd-amdhsa--gfx950"
.text
.globl standalone__gqa_softmax__near_ridge_kernel
.p2align 8
.type standalone__gqa_softmax__near_ridge_kernel,@function
standalone__gqa_softmax__near_ridge_kernel:
    s_cmp_ge_u32 s2, 256
    s_cbranch_scc1 L_end
    s_load_dwordx4 s[4:7], s[0:1], 0
    s_load_dwordx4 s[40:43], s[0:1], 16
    s_load_dwordx4 s[56:59], s[0:1], 32
    v_lshrrev_b32 v224, 6, v0
    v_and_b32 v1, 63, v0
    v_readfirstlane_b32 s74, v224
    s_and_b32 s44, s2, 7
    s_lshr_b32 s45, s2, 5
    s_lshl_b32 s44, s44, 3
    s_add_u32 s44, s44, s45
    s_lshl_b32 s72, s44, 19
    s_bfe_u32 s45, s2, 0x10003
    s_lshl_b32 s44, s44, 1
    s_add_u32 s44, s44, s45
    s_mul_i32 s46, s44, 49152
    s_bfe_u32 s47, s2, 0x10004
    s_mul_i32 s52, s47, 12288
    s_sub_u32 s53, 12288, s52
    s_lshr_b32 s49, s74, 1
    s_and_b32 s50, s74, 1
    s_lshl_b32 s47, s47, 1
    s_add_u32 s47, s47, s49
    s_lshl_b32 s47, s47, 17
    s_add_u32 s45, s47, s72
    s_lshl_b32 s48, s49, 16
    s_lshl_b32 s24, s50, 13
    s_add_u32 s28, s48, s24
    s_add_u32 s25, s24, 4096
    s_mov_b64 s[26:27], s[24:25]
    s_add_u32 s29, s28, 4096
    s_add_u32 s30, s28, 16384
    s_add_u32 s31, s28, 20480
    s_lshl_b32 s54, s74, 6
    s_lshl_b32 s55, s74, 10
    v_lshrrev_b32 v224, 4, v1
    v_and_b32 v225, 15, v1
    v_xor_b32 v226, v225, v224
    v_lshlrev_b32 v227, 8, v224
    v_lshl_add_u32 v12, v226, 4, v227
    v_xor_b32 v13, 64, v12
    v_xor_b32 v14, 128, v12
    v_xor_b32 v15, 192, v12
    v_lshlrev_b32 v229, 8, v225
    v_lshl_add_u32 v229, v226, 4, v229
    v_add_u32 v20, s48, v229
    v_lshlrev_b32 v226, 1, v224
    v_xor_b32 v226, v225, v226
    v_lshl_add_u32 v16, v226, 4, v227
    v_xor_b32 v17, 0x80, v16
    v_xor_b32 v21, 64, v20
    v_xor_b32 v22, 128, v20
    v_xor_b32 v23, 192, v20
    v_xor_b32 v248, s54, v12
    v_add_u32 v248, s55, v248
    s_mov_b32 s10, 49152
    s_mov_b32 s11, 0x20000
    s_mov_b32 s14, 0x20000
    s_mov_b32 s15, 0x20000
    s_mov_b32 s18, 0x20000
    s_mov_b32 s19, 0x20000
    s_waitcnt lgkmcnt(0)
    s_add_u32 s8, s4, s46
    s_addc_u32 s9, s5, 0
    s_add_u32 s12, s6, s45
    s_addc_u32 s13, s7, 0
    s_add_u32 s16, s40, s45
    s_addc_u32 s17, s41, 0
    s_add_u32 s51, s52, 0
    buffer_load_dwordx4 v[72:75], v248, s[8:11], s51 offen
    s_add_u32 s51, s52, 24576
    buffer_load_dwordx4 v[76:79], v248, s[8:11], s51 offen
    s_add_u32 s51, s52, 4096
    buffer_load_dwordx4 v[80:83], v248, s[8:11], s51 offen
    s_add_u32 s51, s52, 28672
    buffer_load_dwordx4 v[84:87], v248, s[8:11], s51 offen
    s_add_u32 s51, s52, 8192
    buffer_load_dwordx4 v[88:91], v248, s[8:11], s51 offen
    s_add_u32 s51, s52, 32768
    buffer_load_dwordx4 v[92:95], v248, s[8:11], s51 offen
    s_mov_b32 m0, s28
    s_nop 0
    buffer_load_dwordx4 v12, s[12:15], s24 offen offset:0 nt lds
    buffer_load_dwordx4 v13, s[12:15], s24 offen offset:1024 nt lds
    buffer_load_dwordx4 v14, s[12:15], s24 offen offset:2048 nt lds
    buffer_load_dwordx4 v15, s[12:15], s24 offen offset:3072 nt lds
    s_getpc_b64 s[92:93]
L_pc:
    s_lshr_b32 s94, s2, 3
    s_lshl_b32 s94, s94, 2
    s_add_u32 s94, s94, s74
    s_mul_i32 s94, s94, 192
    s_min_u32 s94, s94, L_end-L_pc-128
    s_add_u32 s92, s92, s94
    s_addc_u32 s93, s93, 0
    s_load_dword s95, s[92:93], 0
    s_load_dword s94, s[92:93], 64
    s_load_dword s75, s[92:93], 128
    s_mul_i32 s3, s50, 24576
    s_add_u32 s46, s46, s3
    s_add_u32 s46, s46, s53
    s_add_u32 s20, s42, s46
    s_addc_u32 s21, s43, 0
    s_mov_b32 s22, 12288
    s_mov_b32 s23, 0x20000
    s_lshl_b32 s51, s44, 1
    s_bfe_u32 s4, s2, 0x10004
    s_add_u32 s51, s51, s4
    s_lshl_b32 s51, s51, 2
    s_add_u32 s51, s51, s74
    s_lshr_b32 s4, s51, 10
    s_mul_i32 s4, s4, 8388608
    s_lshl_b32 s51, s51, 10
    s_add_u32 s51, s51, s4
    s_add_u32 s51, s51, 0x200000
    s_add_u32 s4, s58, s51
    s_addc_u32 s5, s59, 0
    s_xor_b32 s51, s51, 0x1000
    s_add_u32 s32, s58, s51
    s_addc_u32 s33, s59, 0
    s_mov_b32 s34, 8389632
    s_mov_b32 s35, 0x20000
    s_mov_b32 s44, s56
    s_mov_b32 s45, s57
    s_mov_b32 s46, 256
    s_mov_b32 s47, 0x20000
    s_and_b32 s59, s2, 0xfc
    s_and_b32 s73, s2, 3
    s_lshl_b32 s73, s73, 3
    s_lshl_b32 s73, 1, s73
    v_mov_b32 v18, s73
    v_lshlrev_b32 v19, 8, v1
    v_add_u32 v19, s59, v19
    s_xor_b32 s59, s59, 16
    s_cmp_eq_u32 s74, 0
    s_cselect_b32 s39, 4, 99
    s_bfe_u32 s51, s2, 0x10003
    s_add_u32 s39, s39, s51
    s_mov_b32 s38, 0
    s_mov_b32 s67, 0
    s_mov_b32 s36, 0x3e0293ee
    s_mov_b32 s37, 0x3e0293ee
    s_add_u32 s60, s48, 16384
    s_lshl_b32 s61, s49, 7
    v_lshrrev_b32 v226, 2, v1
    v_and_b32 v227, 7, v226
    v_lshlrev_b32 v227, 5, v227
    v_xor_b32 v227, s61, v227
    v_lshl_add_u32 v227, v226, 8, v227
    v_and_b32 v226, 3, v1
    v_lshl_add_u32 v227, v226, 3, v227
    v_add_u32 v24, s60, v227
    v_xor_b32 v25, 32, v24
    v_xor_b32 v26, 64, v24
    v_xor_b32 v27, 96, v24
    v_xor_b32 v28, 128, v24
    v_xor_b32 v29, 160, v24
    v_xor_b32 v30, 192, v24
    v_xor_b32 v31, 224, v24
    v_lshlrev_b32 v4, 4, v1
    v_lshlrev_b32 v5, 2, v1
    v_lshl_add_u32 v5, s74, 8, v5
    s_lshl_b32 s51, s50, 13
    s_add_u32 s51, s51, s48
    s_add_u32 s51, s51, 32768
    v_add_u32 v2, s51, v4
    v_xor_b32 v3, 65536, v2
    s_add_u32 s51, s55, 114688
    v_add_u32 v249, s51, v4
    s_lshl_b32 s51, s50, 3
    s_add_u32 s51, s51, 131072
    v_lshl_add_u32 v7, v225, 4, s51
    v_lshl_add_u32 v6, s49, 2, v7
    v_lshlrev_b32 v8, 8, v225
    v_and_b32 v227, 16, v1
    v_lshl_add_u32 v8, v227, 1, v8
    v_lshrrev_b32 v227, 5, v1
    v_lshl_add_u32 v8, v227, 4, v8
    v_add_u32 v8, s61, v8
    v_mov_b32 v9, 0
    v_mov_b32 v227, 0x3f803f80
    s_lshr_b32 s3, s3, 1
    s_add_u32 s3, s3, 114688
    s_sub_u32 s3, s3, s48
    v_accvgpr_write_b32 a248, v227
    v_accvgpr_write_b32 a249, v227
    v_accvgpr_write_b32 a250, v227
    v_accvgpr_write_b32 a251, v227
    v_accvgpr_write_b32 a252, -1
    v_accvgpr_write_b32 a253, -1
    v_accvgpr_write_b32 a254, -1
    v_accvgpr_write_b32 a255, -1
    v_add_u32 v250, s3, v20
    v_add_u32 v251, s3, v21
    v_add_u32 v252, s3, v22
    v_add_u32 v253, s3, v23
    s_mov_b32 s56, 1048576
    s_mov_b32 s57, 2097152
    s_mov_b32 s58, 3145728
    s_mov_b32 s64, 4194304
    s_mov_b32 s65, 5242880
    s_mov_b32 s66, 6291456
    s_mov_b32 s61, 7340032
    s_mov_b32 s62, 8388608
    s_mov_b32 s54, 0x8000
    s_mov_b32 s55, 0x8000
    v_mov_b32 v192, 0
    v_mov_b32 v193, 0
    v_mov_b32 v194, 0
    v_mov_b32 v195, 0
    v_mov_b32 v196, 0
    v_mov_b32 v197, 0
    v_mov_b32 v198, 0
    v_mov_b32 v199, 0
    v_mov_b32 v200, 0
    v_mov_b32 v201, 0
    v_mov_b32 v202, 0
    v_mov_b32 v203, 0
    v_mov_b32 v204, 0
    v_mov_b32 v205, 0
    v_mov_b32 v206, 0
    v_mov_b32 v207, 0
    v_mov_b32 v208, 0
    v_mov_b32 v209, 0
    v_mov_b32 v210, 0
    v_mov_b32 v211, 0
    v_mov_b32 v212, 0
    v_mov_b32 v213, 0
    v_mov_b32 v214, 0
    v_mov_b32 v215, 0
    v_mov_b32 v216, 0
    v_mov_b32 v217, 0
    v_mov_b32 v218, 0
    v_mov_b32 v219, 0
    v_mov_b32 v220, 0
    v_mov_b32 v221, 0
    v_mov_b32 v222, 0
    v_mov_b32 v223, 0
    v_accvgpr_write_b32 a244, 0
    v_accvgpr_write_b32 a245, 0
    v_accvgpr_write_b32 a246, 0
    v_accvgpr_write_b32 a247, 0
    s_mov_b64 exec, 0
    s_cmp_eq_u32 s74, 0
    s_cbranch_scc1 L_pg1
    s_cmp_eq_u32 s74, 1
    s_cbranch_scc1 L_pg2
    s_cmp_eq_u32 s74, 2
    s_cbranch_scc1 L_pg3
    s_branch L_pg4
L_back:
    s_mov_b64 exec, -1
    s_waitcnt vmcnt(9)
    v_lshlrev_b32 v56, 16, v72
    v_and_b32 v57, 0xffff0000, v72
    v_lshlrev_b32 v58, 16, v73
    v_and_b32 v59, 0xffff0000, v73
    v_lshlrev_b32 v60, 16, v74
    v_and_b32 v61, 0xffff0000, v74
    v_lshlrev_b32 v62, 16, v75
    v_and_b32 v63, 0xffff0000, v75
    v_pk_mul_f32 v[56:57], v[56:57], s[36:37]
    v_pk_mul_f32 v[58:59], v[58:59], s[36:37]
    s_mov_b32 m0, s29
    s_nop 0
    buffer_load_dwordx4 v12, s[12:15], s25 offen offset:0 nt lds
    v_pk_mul_f32 v[60:61], v[60:61], s[36:37]
    v_pk_mul_f32 v[62:63], v[62:63], s[36:37]
    v_cvt_pk_bf16_f32 v72, v56, v57
    v_cvt_pk_bf16_f32 v73, v58, v59
    v_cvt_pk_bf16_f32 v74, v60, v61
    v_cvt_pk_bf16_f32 v75, v62, v63
    ds_write_b128 v249, v[72:75] offset:0
    s_waitcnt vmcnt(9)
    v_lshlrev_b32 v56, 16, v76
    v_and_b32 v57, 0xffff0000, v76
    v_lshlrev_b32 v58, 16, v77
    buffer_load_dwordx4 v13, s[12:15], s25 offen offset:1024 nt lds
    v_and_b32 v59, 0xffff0000, v77
    v_lshlrev_b32 v60, 16, v78
    v_and_b32 v61, 0xffff0000, v78
    v_lshlrev_b32 v62, 16, v79
    v_and_b32 v63, 0xffff0000, v79
    v_pk_mul_f32 v[56:57], v[56:57], s[36:37]
    v_pk_mul_f32 v[58:59], v[58:59], s[36:37]
    v_pk_mul_f32 v[60:61], v[60:61], s[36:37]
    v_pk_mul_f32 v[62:63], v[62:63], s[36:37]
    v_cvt_pk_bf16_f32 v76, v56, v57
    v_cvt_pk_bf16_f32 v77, v58, v59
    buffer_load_dwordx4 v14, s[12:15], s25 offen offset:2048 nt lds
    v_cvt_pk_bf16_f32 v78, v60, v61
    v_cvt_pk_bf16_f32 v79, v62, v63
    ds_write_b128 v249, v[76:79] offset:12288
    s_waitcnt vmcnt(10)
    v_lshlrev_b32 v56, 16, v80
    v_and_b32 v57, 0xffff0000, v80
    v_lshlrev_b32 v58, 16, v81
    v_and_b32 v59, 0xffff0000, v81
    v_lshlrev_b32 v60, 16, v82
    v_and_b32 v61, 0xffff0000, v82
    v_lshlrev_b32 v62, 16, v83
    buffer_load_dwordx4 v15, s[12:15], s25 offen offset:3072 nt lds
    v_and_b32 v63, 0xffff0000, v83
    v_pk_mul_f32 v[56:57], v[56:57], s[36:37]
    v_pk_mul_f32 v[58:59], v[58:59], s[36:37]
    v_pk_mul_f32 v[60:61], v[60:61], s[36:37]
    v_pk_mul_f32 v[62:63], v[62:63], s[36:37]
    v_cvt_pk_bf16_f32 v80, v56, v57
    v_cvt_pk_bf16_f32 v81, v58, v59
    v_cvt_pk_bf16_f32 v82, v60, v61
    v_cvt_pk_bf16_f32 v83, v62, v63
    ds_write_b128 v249, v[80:83] offset:4096
    s_add_u32 s51, s53, 0
    buffer_load_dwordx4 v[32:35], v248, s[8:11], s51 offen
    s_waitcnt vmcnt(11)
    v_lshlrev_b32 v56, 16, v84
    v_and_b32 v57, 0xffff0000, v84
    v_lshlrev_b32 v58, 16, v85
    v_and_b32 v59, 0xffff0000, v85
    v_lshlrev_b32 v60, 16, v86
    v_and_b32 v61, 0xffff0000, v86
    v_lshlrev_b32 v62, 16, v87
    v_and_b32 v63, 0xffff0000, v87
    v_pk_mul_f32 v[56:57], v[56:57], s[36:37]
    v_pk_mul_f32 v[58:59], v[58:59], s[36:37]
    s_add_u32 s51, s53, 24576
    buffer_load_dwordx4 v[36:39], v248, s[8:11], s51 offen
    v_pk_mul_f32 v[60:61], v[60:61], s[36:37]
    v_pk_mul_f32 v[62:63], v[62:63], s[36:37]
    v_cvt_pk_bf16_f32 v84, v56, v57
    v_cvt_pk_bf16_f32 v85, v58, v59
    v_cvt_pk_bf16_f32 v86, v60, v61
    v_cvt_pk_bf16_f32 v87, v62, v63
    ds_write_b128 v249, v[84:87] offset:16384
    s_waitcnt vmcnt(11)
    v_lshlrev_b32 v56, 16, v88
    v_and_b32 v57, 0xffff0000, v88
    v_lshlrev_b32 v58, 16, v89
    s_add_u32 s51, s53, 4096
    buffer_load_dwordx4 v[40:43], v248, s[8:11], s51 offen
    v_and_b32 v59, 0xffff0000, v89
    v_lshlrev_b32 v60, 16, v90
    v_and_b32 v61, 0xffff0000, v90
    v_lshlrev_b32 v62, 16, v91
    v_and_b32 v63, 0xffff0000, v91
    v_pk_mul_f32 v[56:57], v[56:57], s[36:37]
    v_pk_mul_f32 v[58:59], v[58:59], s[36:37]
    v_pk_mul_f32 v[60:61], v[60:61], s[36:37]
    v_pk_mul_f32 v[62:63], v[62:63], s[36:37]
    v_cvt_pk_bf16_f32 v88, v56, v57
    v_cvt_pk_bf16_f32 v89, v58, v59
    s_add_u32 s51, s53, 28672
    buffer_load_dwordx4 v[44:47], v248, s[8:11], s51 offen
    v_cvt_pk_bf16_f32 v90, v60, v61
    v_cvt_pk_bf16_f32 v91, v62, v63
    ds_write_b128 v249, v[88:91] offset:8192
    s_waitcnt vmcnt(12)
    v_lshlrev_b32 v56, 16, v92
    v_and_b32 v57, 0xffff0000, v92
    v_lshlrev_b32 v58, 16, v93
    v_and_b32 v59, 0xffff0000, v93
    v_lshlrev_b32 v60, 16, v94
    v_and_b32 v61, 0xffff0000, v94
    v_lshlrev_b32 v62, 16, v95
    s_add_u32 s51, s53, 8192
    buffer_load_dwordx4 v[48:51], v248, s[8:11], s51 offen
    v_and_b32 v63, 0xffff0000, v95
    v_pk_mul_f32 v[56:57], v[56:57], s[36:37]
    v_pk_mul_f32 v[58:59], v[58:59], s[36:37]
    v_pk_mul_f32 v[60:61], v[60:61], s[36:37]
    v_pk_mul_f32 v[62:63], v[62:63], s[36:37]
    v_cvt_pk_bf16_f32 v92, v56, v57
    v_cvt_pk_bf16_f32 v93, v58, v59
    v_cvt_pk_bf16_f32 v94, v60, v61
    v_cvt_pk_bf16_f32 v95, v62, v63
    ds_write_b128 v249, v[92:95] offset:20480
    s_add_u32 s51, s53, 32768
    buffer_load_dwordx4 v[52:55], v248, s[8:11], s51 offen
    s_waitcnt lgkmcnt(0)
    s_barrier
    ds_read_b128 a[0:3], v250 offset:0
    ds_read_b128 a[4:7], v251 offset:0
    ds_read_b128 a[8:11], v252 offset:0
    ds_read_b128 a[12:15], v253 offset:0
    ds_read_b128 a[16:19], v250 offset:4096
    ds_read_b128 a[20:23], v251 offset:4096
    ds_read_b128 a[24:27], v252 offset:4096
    ds_read_b128 a[28:31], v253 offset:4096
    ds_read_b128 a[32:35], v250 offset:8192
    ds_read_b128 a[36:39], v251 offset:8192
    ds_read_b128 a[40:43], v252 offset:8192
    ds_read_b128 a[44:47], v253 offset:8192
    s_mov_b32 m0, s30
    s_nop 0
    buffer_load_dwordx4 v16, s[16:19], s26 offen offset:0 nt lds
    buffer_load_dwordx4 v17, s[16:19], s26 offen offset:1024 nt lds
    buffer_load_dwordx4 v16, s[16:19], s26 offen offset:2048 nt lds
    buffer_load_dwordx4 v17, s[16:19], s26 offen offset:3072 nt lds
    s_waitcnt vmcnt(10)
    s_barrier
    ds_read_b128 a[96:99], v20 offset:0
    ds_read_b128 a[100:103], v21 offset:0
    ds_read_b128 a[104:107], v22 offset:0
    ds_read_b128 a[108:111], v23 offset:0
    ds_read_b128 a[112:115], v20 offset:4096
    ds_read_b128 a[116:119], v21 offset:4096
    ds_read_b128 a[120:123], v22 offset:4096
    ds_read_b128 a[124:127], v23 offset:4096
    ds_read_b128 a[128:131], v20 offset:8192
    ds_read_b128 a[132:135], v21 offset:8192
    ds_read_b128 a[136:139], v22 offset:8192
    ds_read_b128 a[140:143], v23 offset:8192
    ds_read_b128 a[144:147], v20 offset:12288
    ds_read_b128 a[148:151], v21 offset:12288
    ds_read_b128 a[152:155], v22 offset:12288
    ds_read_b128 a[156:159], v23 offset:12288
    v_xor_b32 v20, 0x8000, v20
    v_xor_b32 v21, 0x8000, v21
    v_xor_b32 v22, 0x8000, v22
    v_xor_b32 v23, 0x8000, v23
    s_mov_b64 s[8:9], s[4:5]
    s_mov_b32 s10, 8389632
    s_mov_b32 s63, 0
    s_add_u32 s24, s24, 16384
    s_add_u32 s25, s25, 16384
    s_xor_b64 s[28:29], s[28:29], s[54:55]
    s_mov_b32 m0, s31
    s_waitcnt lgkmcnt(12)
    v_mfma_f32_16x16x32_bf16 v[224:227], a[96:99], a[0:3], 0
    buffer_load_dwordx4 v16, s[16:19], s27 offen offset:0 nt lds
    v_mfma_f32_16x16x32_bf16 v[224:227], a[100:103], a[4:7], v[224:227]
    v_mfma_f32_16x16x32_bf16 v[224:227], a[104:107], a[8:11], v[224:227]
    s_waitcnt lgkmcnt(8)
    v_mfma_f32_16x16x32_bf16 v[224:227], a[108:111], a[12:15], v[224:227]
    v_mfma_f32_16x16x32_bf16 v[228:231], a[112:115], a[0:3], 0
    v_mfma_f32_16x16x32_bf16 v[228:231], a[116:119], a[4:7], v[228:231]
    buffer_load_dwordx4 v17, s[16:19], s27 offen offset:1024 nt lds
    v_mfma_f32_16x16x32_bf16 v[228:231], a[120:123], a[8:11], v[228:231]
    v_exp_f32 v224, v224
    s_waitcnt lgkmcnt(4)
    v_mfma_f32_16x16x32_bf16 v[228:231], a[124:127], a[12:15], v[228:231]
    v_exp_f32 v225, v225
    v_mfma_f32_16x16x32_bf16 v[232:235], a[128:131], a[0:3], 0
    v_cvt_pk_bf16_f32 v64, v224, v225
    v_exp_f32 v226, v226
    s_waitcnt vmcnt(11)
    v_mfma_f32_16x16x32_bf16 v[232:235], a[132:135], a[4:7], v[232:235]
    v_exp_f32 v227, v227
    v_lshlrev_b32 v56, 16, v32
    v_and_b32 v57, 0xffff0000, v32
    v_lshlrev_b32 v58, 16, v33
    v_and_b32 v59, 0xffff0000, v33
    v_lshlrev_b32 v60, 16, v34
    v_and_b32 v61, 0xffff0000, v34
    v_mfma_f32_16x16x32_bf16 v[232:235], a[136:139], a[8:11], v[232:235]
    v_cvt_pk_bf16_f32 v65, v226, v227
    v_exp_f32 v228, v228
    v_lshlrev_b32 v62, 16, v35
    v_and_b32 v63, 0xffff0000, v35
    v_mul_f32 v56, s36, v56
    v_mul_f32 v57, s36, v57
    s_waitcnt lgkmcnt(0)
    v_mfma_f32_16x16x32_bf16 v[232:235], a[140:143], a[12:15], v[232:235]
    v_exp_f32 v229, v229
    v_mul_f32 v58, s36, v58
    v_mul_f32 v59, s36, v59
    v_mul_f32 v60, s36, v60
    v_mul_f32 v61, s36, v61
    v_mul_f32 v62, s36, v62
    v_mul_f32 v63, s36, v63
    v_mfma_f32_16x16x32_bf16 v[236:239], a[144:147], a[0:3], 0
    v_cvt_pk_bf16_f32 v66, v228, v229
    v_exp_f32 v230, v230
    v_cvt_pk_bf16_f32 v32, v56, v57
    v_cvt_pk_bf16_f32 v33, v58, v59
    v_cvt_pk_bf16_f32 v34, v60, v61
    v_cvt_pk_bf16_f32 v35, v62, v63
    v_mfma_f32_16x16x32_bf16 v[236:239], a[148:151], a[4:7], v[236:239]
    ds_write_b128 v249, v[32:35] offset:24576
    buffer_load_dwordx4 v16, s[16:19], s27 offen offset:2048 nt lds
    v_exp_f32 v231, v231
    s_branch L_pg1
.p2align 12
L_pg1:
    s_cbranch_execz L_back
    s_waitcnt vmcnt(11)
    v_mfma_f32_16x16x32_bf16 v[236:239], a[152:155], a[8:11], v[236:239]
    v_cvt_pk_bf16_f32 v67, v230, v231
    v_exp_f32 v232, v232
    v_lshlrev_b32 v56, 16, v36
    v_and_b32 v57, 0xffff0000, v36
    v_lshlrev_b32 v58, 16, v37
    v_and_b32 v59, 0xffff0000, v37
    v_lshlrev_b32 v60, 16, v38
    v_mfma_f32_16x16x32_bf16 v[236:239], a[156:159], a[12:15], v[236:239]
    v_exp_f32 v233, v233
    v_and_b32 v61, 0xffff0000, v38
    v_lshlrev_b32 v62, 16, v39
    v_and_b32 v63, 0xffff0000, v39
    v_mul_f32 v56, s36, v56
    v_mul_f32 v57, s36, v57
    v_mul_f32 v58, s36, v58
    v_mfma_f32_16x16x32_bf16 v[224:227], a[96:99], a[16:19], 0
    v_cvt_pk_bf16_f32 v68, v232, v233
    v_exp_f32 v234, v234
    v_mul_f32 v59, s36, v59
    v_mul_f32 v60, s36, v60
    v_mul_f32 v61, s36, v61
    v_mul_f32 v62, s36, v62
    v_mul_f32 v63, s36, v63
    v_mfma_f32_16x16x32_bf16 v[224:227], a[100:103], a[20:23], v[224:227]
    buffer_load_dwordx4 v17, s[16:19], s27 offen offset:3072 nt lds
    v_exp_f32 v235, v235
    v_cvt_pk_bf16_f32 v36, v56, v57
    v_cvt_pk_bf16_f32 v37, v58, v59
    v_cvt_pk_bf16_f32 v38, v60, v61
    v_cvt_pk_bf16_f32 v39, v62, v63
    v_mfma_f32_16x16x32_bf16 v[224:227], a[104:107], a[24:27], v[224:227]
    ds_write_b128 v249, v[36:39] offset:36864
    v_cvt_pk_bf16_f32 v69, v234, v235
    v_exp_f32 v236, v236
    s_waitcnt vmcnt(11)
    s_mov_b32 m0, s28
    s_add_u32 s26, s26, 16384
    s_add_u32 s27, s27, 16384
    v_mfma_f32_16x16x32_bf16 v[224:227], a[108:111], a[28:31], v[224:227]
    v_exp_f32 v237, v237
    v_lshlrev_b32 v56, 16, v40
    v_and_b32 v57, 0xffff0000, v40
    v_lshlrev_b32 v58, 16, v41
    v_and_b32 v59, 0xffff0000, v41
    v_lshlrev_b32 v60, 16, v42
    v_and_b32 v61, 0xffff0000, v42
    s_xor_b64 s[30:31], s[30:31], s[54:55]
    v_mfma_f32_16x16x32_bf16 v[228:231], a[112:115], a[16:19], 0
    v_cvt_pk_bf16_f32 v70, v236, v237
    v_exp_f32 v238, v238
    v_lshlrev_b32 v62, 16, v43
    v_and_b32 v63, 0xffff0000, v43
    v_mul_f32 v56, s36, v56
    v_mul_f32 v57, s36, v57
    v_mul_f32 v58, s36, v58
    v_mfma_f32_16x16x32_bf16 v[228:231], a[116:119], a[20:23], v[228:231]
    v_exp_f32 v239, v239
    v_mul_f32 v59, s36, v59
    v_mul_f32 v60, s36, v60
    v_mul_f32 v61, s36, v61
    v_mul_f32 v62, s36, v62
    v_mul_f32 v63, s36, v63
    v_cvt_pk_bf16_f32 v40, v56, v57
    v_mfma_f32_16x16x32_bf16 v[228:231], a[120:123], a[24:27], v[228:231]
    v_cvt_pk_bf16_f32 v71, v238, v239
    v_exp_f32 v224, v224
    v_cvt_pk_bf16_f32 v41, v58, v59
    v_cvt_pk_bf16_f32 v42, v60, v61
    v_cvt_pk_bf16_f32 v43, v62, v63
    v_mfma_f32_16x16x32_bf16 v[228:231], a[124:127], a[28:31], v[228:231]
    ds_write_b128 v249, v[40:43] offset:28672
    buffer_load_dwordx4 v12, s[12:15], s24 offen offset:0 nt lds
    v_exp_f32 v225, v225
    s_waitcnt vmcnt(11)
    v_mfma_f32_16x16x32_bf16 v[232:235], a[128:131], a[16:19], 0
    v_cvt_pk_bf16_f32 v96, v224, v225
    v_exp_f32 v226, v226
    v_lshlrev_b32 v56, 16, v44
    v_and_b32 v57, 0xffff0000, v44
    v_lshlrev_b32 v58, 16, v45
    v_and_b32 v59, 0xffff0000, v45
    v_lshlrev_b32 v60, 16, v46
    v_mfma_f32_16x16x32_bf16 v[232:235], a[132:135], a[20:23], v[232:235]
    v_exp_f32 v227, v227
    v_and_b32 v61, 0xffff0000, v46
    v_lshlrev_b32 v62, 16, v47
    v_and_b32 v63, 0xffff0000, v47
    v_mul_f32 v56, s36, v56
    v_mul_f32 v57, s36, v57
    v_mul_f32 v58, s36, v58
    v_mfma_f32_16x16x32_bf16 v[232:235], a[136:139], a[24:27], v[232:235]
    v_cvt_pk_bf16_f32 v97, v226, v227
    v_exp_f32 v228, v228
    v_mul_f32 v59, s36, v59
    v_mul_f32 v60, s36, v60
    v_mul_f32 v61, s36, v61
    v_mul_f32 v62, s36, v62
    v_mul_f32 v63, s36, v63
    v_mfma_f32_16x16x32_bf16 v[232:235], a[140:143], a[28:31], v[232:235]
    buffer_load_dwordx4 v13, s[12:15], s24 offen offset:1024 nt lds
    v_exp_f32 v229, v229
    v_cvt_pk_bf16_f32 v44, v56, v57
    v_cvt_pk_bf16_f32 v45, v58, v59
    v_cvt_pk_bf16_f32 v46, v60, v61
    v_cvt_pk_bf16_f32 v47, v62, v63
    v_mfma_f32_16x16x32_bf16 v[236:239], a[144:147], a[16:19], 0
    ds_write_b128 v249, v[44:47] offset:40960
    v_cvt_pk_bf16_f32 v98, v228, v229
    v_exp_f32 v230, v230
    s_waitcnt vmcnt(11)
    v_mfma_f32_16x16x32_bf16 v[236:239], a[148:151], a[20:23], v[236:239]
    v_exp_f32 v231, v231
    v_lshlrev_b32 v56, 16, v48
    v_and_b32 v57, 0xffff0000, v48
    v_lshlrev_b32 v58, 16, v49
    v_and_b32 v59, 0xffff0000, v49
    v_lshlrev_b32 v60, 16, v50
    v_and_b32 v61, 0xffff0000, v50
    v_mfma_f32_16x16x32_bf16 v[236:239], a[152:155], a[24:27], v[236:239]
    v_cvt_pk_bf16_f32 v99, v230, v231
    v_exp_f32 v232, v232
    v_lshlrev_b32 v62, 16, v51
    v_and_b32 v63, 0xffff0000, v51
    v_mul_f32 v56, s36, v56
    v_mul_f32 v57, s36, v57
    v_mul_f32 v58, s36, v58
    v_mfma_f32_16x16x32_bf16 v[236:239], a[156:159], a[28:31], v[236:239]
    v_exp_f32 v233, v233
    v_mul_f32 v59, s36, v59
    v_mul_f32 v60, s36, v60
    v_mul_f32 v61, s36, v61
    v_mul_f32 v62, s36, v62
    v_mul_f32 v63, s36, v63
    v_cvt_pk_bf16_f32 v48, v56, v57
    v_mfma_f32_16x16x32_bf16 v[224:227], a[96:99], a[32:35], 0
    v_cvt_pk_bf16_f32 v100, v232, v233
    v_exp_f32 v234, v234
    v_cvt_pk_bf16_f32 v49, v58, v59
    v_cvt_pk_bf16_f32 v50, v60, v61
    v_cvt_pk_bf16_f32 v51, v62, v63
    v_mfma_f32_16x16x32_bf16 v[224:227], a[100:103], a[36:39], v[224:227]
    ds_write_b128 v249, v[48:51] offset:32768
    buffer_load_dwordx4 v14, s[12:15], s24 offen offset:2048 nt lds
    v_exp_f32 v235, v235
    s_waitcnt vmcnt(11)
    v_mfma_f32_16x16x32_bf16 v[224:227], a[104:107], a[40:43], v[224:227]
    v_cvt_pk_bf16_f32 v101, v234, v235
    v_exp_f32 v236, v236
    v_lshlrev_b32 v56, 16, v52
    v_and_b32 v57, 0xffff0000, v52
    v_lshlrev_b32 v58, 16, v53
    v_and_b32 v59, 0xffff0000, v53
    v_lshlrev_b32 v60, 16, v54
    v_mfma_f32_16x16x32_bf16 v[224:227], a[108:111], a[44:47], v[224:227]
    v_exp_f32 v237, v237
    v_and_b32 v61, 0xffff0000, v54
    v_lshlrev_b32 v62, 16, v55
    v_and_b32 v63, 0xffff0000, v55
    v_mul_f32 v56, s36, v56
    v_mul_f32 v57, s36, v57
    v_mul_f32 v58, s36, v58
    v_mfma_f32_16x16x32_bf16 v[228:231], a[112:115], a[32:35], 0
    v_cvt_pk_bf16_f32 v102, v236, v237
    v_exp_f32 v238, v238
    v_mul_f32 v59, s36, v59
    v_mul_f32 v60, s36, v60
    v_mul_f32 v61, s36, v61
    v_mul_f32 v62, s36, v62
    v_mul_f32 v63, s36, v63
    v_mfma_f32_16x16x32_bf16 v[228:231], a[116:119], a[36:39], v[228:231]
    v_exp_f32 v239, v239
    v_cvt_pk_bf16_f32 v52, v56, v57
    v_cvt_pk_bf16_f32 v53, v58, v59
    v_cvt_pk_bf16_f32 v54, v60, v61
    v_cvt_pk_bf16_f32 v55, v62, v63
    v_mfma_f32_16x16x32_bf16 v[228:231], a[120:123], a[40:43], v[228:231]
    ds_write_b128 v249, v[52:55] offset:45056
    v_cvt_pk_bf16_f32 v103, v238, v239
    v_exp_f32 v224, v224
    v_mfma_f32_16x16x32_bf16 v[228:231], a[124:127], a[44:47], v[228:231]
    buffer_load_dwordx4 v15, s[12:15], s24 offen offset:3072 nt lds
    v_exp_f32 v225, v225
    v_mfma_f32_16x16x32_bf16 v[232:235], a[128:131], a[32:35], 0
    v_cvt_pk_bf16_f32 v128, v224, v225
    v_exp_f32 v226, v226
    s_waitcnt lgkmcnt(0)
    s_barrier
    v_mfma_f32_16x16x32_bf16 v[232:235], a[132:135], a[36:39], v[232:235]
    ds_read_b128 a[48:51], v250 offset:24576
    v_exp_f32 v227, v227
    s_mov_b32 m0, s29
    v_mfma_f32_16x16x32_bf16 v[232:235], a[136:139], a[40:43], v[232:235]
    ds_read_b128 a[52:55], v251 offset:24576
    v_cvt_pk_bf16_f32 v129, v226, v227
    v_exp_f32 v228, v228
    v_mfma_f32_16x16x32_bf16 v[232:235], a[140:143], a[44:47], v[232:235]
    ds_read_b128 a[56:59], v252 offset:24576
    buffer_load_dwordx4 v12, s[12:15], s25 offen offset:0 nt lds
    v_exp_f32 v229, v229
    v_mfma_f32_16x16x32_bf16 v[236:239], a[144:147], a[32:35], 0
    ds_read_b128 a[60:63], v253 offset:24576
    v_cvt_pk_bf16_f32 v130, v228, v229
    v_exp_f32 v230, v230
    v_mfma_f32_16x16x32_bf16 v[236:239], a[148:151], a[36:39], v[236:239]
    ds_read_b128 a[64:67], v250 offset:28672
    v_exp_f32 v231, v231
    v_mfma_f32_16x16x32_bf16 v[236:239], a[152:155], a[40:43], v[236:239]
    ds_read_b128 a[68:71], v251 offset:28672
    v_cvt_pk_bf16_f32 v131, v230, v231
    v_exp_f32 v232, v232
    v_mfma_f32_16x16x32_bf16 v[236:239], a[156:159], a[44:47], v[236:239]
    ds_read_b128 a[72:75], v252 offset:28672
    v_exp_f32 v233, v233
    s_waitcnt lgkmcnt(3)
    v_mfma_f32_16x16x32_bf16 v[224:227], a[96:99], a[48:51], 0
    ds_read_b128 a[76:79], v253 offset:28672
    v_cvt_pk_bf16_f32 v132, v232, v233
    v_exp_f32 v234, v234
    v_mfma_f32_16x16x32_bf16 v[224:227], a[100:103], a[52:55], v[224:227]
    ds_read_b128 a[80:83], v250 offset:32768
    buffer_load_dwordx4 v13, s[12:15], s25 offen offset:1024 nt lds
    v_exp_f32 v235, v235
    v_mfma_f32_16x16x32_bf16 v[224:227], a[104:107], a[56:59], v[224:227]
    ds_read_b128 a[84:87], v251 offset:32768
    v_cvt_pk_bf16_f32 v133, v234, v235
    v_exp_f32 v236, v236
    v_mfma_f32_16x16x32_bf16 v[224:227], a[108:111], a[60:63], v[224:227]
    ds_read_b128 a[88:91], v252 offset:32768
    v_exp_f32 v237, v237
    v_mfma_f32_16x16x32_bf16 v[228:231], a[112:115], a[48:51], 0
    ds_read_b128 a[92:95], v253 offset:32768
    v_cvt_pk_bf16_f32 v134, v236, v237
    v_exp_f32 v238, v238
    v_mfma_f32_16x16x32_bf16 v[228:231], a[116:119], a[52:55], v[228:231]
    buffer_load_dwordx4 v14, s[12:15], s25 offen offset:2048 nt lds
    v_exp_f32 v239, v239
    v_mfma_f32_16x16x32_bf16 v[228:231], a[120:123], a[56:59], v[228:231]
    v_cvt_pk_bf16_f32 v135, v238, v239
    v_exp_f32 v224, v224
    v_mfma_f32_16x16x32_bf16 v[228:231], a[124:127], a[60:63], v[228:231]
    v_exp_f32 v225, v225
    v_mfma_f32_16x16x32_bf16 v[232:235], a[128:131], a[48:51], 0
    v_cvt_pk_bf16_f32 v160, v224, v225
    v_exp_f32 v226, v226
    v_mfma_f32_16x16x32_bf16 v[232:235], a[132:135], a[52:55], v[232:235]
    buffer_load_dwordx4 v15, s[12:15], s25 offen offset:3072 nt lds
    v_exp_f32 v227, v227
    v_mfma_f32_16x16x32_bf16 v[232:235], a[136:139], a[56:59], v[232:235]
    v_cvt_pk_bf16_f32 v161, v226, v227
    v_exp_f32 v228, v228
    s_mov_b32 m0, s30
    v_mfma_f32_16x16x32_bf16 v[232:235], a[140:143], a[60:63], v[232:235]
    v_exp_f32 v229, v229
    s_add_u32 s24, s24, 16384
    s_add_u32 s25, s25, 16384
    v_mfma_f32_16x16x32_bf16 v[236:239], a[144:147], a[48:51], 0
    v_cvt_pk_bf16_f32 v162, v228, v229
    v_exp_f32 v230, v230
    s_xor_b64 s[28:29], s[28:29], s[54:55]
    v_mfma_f32_16x16x32_bf16 v[236:239], a[148:151], a[52:55], v[236:239]
    buffer_load_dwordx4 v16, s[16:19], s26 offen offset:0 nt lds
    v_exp_f32 v231, v231
    v_mfma_f32_16x16x32_bf16 v[236:239], a[152:155], a[56:59], v[236:239]
    v_cvt_pk_bf16_f32 v163, v230, v231
    v_exp_f32 v232, v232
    v_mfma_f32_16x16x32_bf16 v[236:239], a[156:159], a[60:63], v[236:239]
    v_exp_f32 v233, v233
    s_waitcnt lgkmcnt(4)
    v_mfma_f32_16x16x32_bf16 v[224:227], a[96:99], a[64:67], 0
    v_cvt_pk_bf16_f32 v164, v232, v233
    v_exp_f32 v234, v234
    v_mfma_f32_16x16x32_bf16 v[224:227], a[100:103], a[68:71], v[224:227]
    buffer_load_dwordx4 v17, s[16:19], s26 offen offset:1024 nt lds
    v_exp_f32 v235, v235
    v_mfma_f32_16x16x32_bf16 v[224:227], a[104:107], a[72:75], v[224:227]
    v_cvt_pk_bf16_f32 v165, v234, v235
    v_exp_f32 v236, v236
    v_mfma_f32_16x16x32_bf16 v[224:227], a[108:111], a[76:79], v[224:227]
    v_exp_f32 v237, v237
    v_mfma_f32_16x16x32_bf16 v[228:231], a[112:115], a[64:67], 0
    v_cvt_pk_bf16_f32 v166, v236, v237
    v_exp_f32 v238, v238
    v_mfma_f32_16x16x32_bf16 v[228:231], a[116:119], a[68:71], v[228:231]
    buffer_load_dwordx4 v16, s[16:19], s26 offen offset:2048 nt lds
    v_exp_f32 v239, v239
    v_mfma_f32_16x16x32_bf16 v[228:231], a[120:123], a[72:75], v[228:231]
    v_cvt_pk_bf16_f32 v167, v238, v239
    v_exp_f32 v224, v224
    v_mfma_f32_16x16x32_bf16 v[228:231], a[124:127], a[76:79], v[228:231]
    v_exp_f32 v225, v225
    v_mfma_f32_16x16x32_bf16 v[232:235], a[128:131], a[64:67], 0
    v_cvt_pk_bf16_f32 v240, v224, v225
    v_exp_f32 v226, v226
    v_mfma_f32_16x16x32_bf16 v[232:235], a[132:135], a[68:71], v[232:235]
    buffer_load_dwordx4 v17, s[16:19], s26 offen offset:3072 nt lds
    v_exp_f32 v227, v227
    v_mfma_f32_16x16x32_bf16 v[232:235], a[136:139], a[72:75], v[232:235]
    v_cvt_pk_bf16_f32 v241, v226, v227
    v_exp_f32 v228, v228
    s_mov_b32 m0, s31
    v_mfma_f32_16x16x32_bf16 v[232:235], a[140:143], a[76:79], v[232:235]
    v_exp_f32 v229, v229
    s_waitcnt vmcnt(12)
    s_barrier
    v_mfma_f32_16x16x32_bf16 v[236:239], a[144:147], a[64:67], 0
    v_cvt_pk_bf16_f32 v242, v228, v229
    v_exp_f32 v230, v230
    v_mfma_f32_16x16x32_bf16 v[236:239], a[148:151], a[68:71], v[236:239]
    ds_read_b64_tr_b16 a[192:193], v28 offset:0
    ds_read_b64_tr_b16 a[194:195], v28 offset:4096
    v_exp_f32 v231, v231
    v_mfma_f32_16x16x32_bf16 v[236:239], a[152:155], a[72:75], v[236:239]
    ds_read_b64_tr_b16 a[196:197], v28 offset:8192
    v_cvt_pk_bf16_f32 v243, v230, v231
    v_exp_f32 v232, v232
    v_mfma_f32_16x16x32_bf16 v[236:239], a[156:159], a[76:79], v[236:239]
    buffer_load_dwordx4 v16, s[16:19], s27 offen offset:0 nt lds
    v_exp_f32 v233, v233
    s_waitcnt lgkmcnt(3)
    v_mfma_f32_16x16x32_bf16 v[224:227], a[96:99], a[80:83], 0
    v_cvt_pk_bf16_f32 v244, v232, v233
    v_exp_f32 v234, v234
    v_mfma_f32_16x16x32_bf16 v[224:227], a[100:103], a[84:87], v[224:227]
    ds_read_b64_tr_b16 a[198:199], v28 offset:12288
    v_exp_f32 v235, v235
    v_mfma_f32_16x16x32_bf16 v[224:227], a[104:107], a[88:91], v[224:227]
    v_cvt_pk_bf16_f32 v245, v234, v235
    v_exp_f32 v236, v236
    v_mfma_f32_16x16x32_bf16 v[224:227], a[108:111], a[92:95], v[224:227]
    ds_read_b64_tr_b16 a[200:201], v29 offset:0
    buffer_load_dwordx4 v17, s[16:19], s27 offen offset:1024 nt lds
    v_exp_f32 v237, v237
    v_mfma_f32_16x16x32_bf16 v[228:231], a[112:115], a[80:83], 0
    v_cvt_pk_bf16_f32 v246, v236, v237
    v_exp_f32 v238, v238
    v_mfma_f32_16x16x32_bf16 v[228:231], a[116:119], a[84:87], v[228:231]
    ds_read_b64_tr_b16 a[202:203], v29 offset:4096
    v_exp_f32 v239, v239
    v_mfma_f32_16x16x32_bf16 v[228:231], a[120:123], a[88:91], v[228:231]
    v_cvt_pk_bf16_f32 v247, v238, v239
    v_exp_f32 v224, v224
    v_mfma_f32_16x16x32_bf16 v[228:231], a[124:127], a[92:95], v[228:231]
    ds_read_b64_tr_b16 a[204:205], v29 offset:8192
    ds_read_b64_tr_b16 a[206:207], v29 offset:12288
    ds_read_b64_tr_b16 a[208:209], v30 offset:0
    buffer_load_dwordx4 v16, s[16:19], s27 offen offset:2048 nt lds
    v_mfma_f32_16x16x32_bf16 v[232:235], a[128:131], a[80:83], 0
    ds_read_b64_tr_b16 a[210:211], v30 offset:4096
    v_exp_f32 v225, v225
    v_mfma_f32_16x16x32_bf16 v[232:235], a[132:135], a[84:87], v[232:235]
    ds_read_b64_tr_b16 a[212:213], v30 offset:8192
    ds_read_b64_tr_b16 a[214:215], v30 offset:12288
    v_cvt_pk_bf16_f32 v248, v224, v225
    v_mfma_f32_16x16x32_bf16 v[232:235], a[136:139], a[88:91], v[232:235]
    ds_read_b64_tr_b16 a[216:217], v31 offset:0
    v_exp_f32 v226, v226
    v_mfma_f32_16x16x32_bf16 v[232:235], a[140:143], a[92:95], v[232:235]
    ds_read_b64_tr_b16 a[218:219], v31 offset:4096
    ds_read_b64_tr_b16 a[220:221], v31 offset:8192
    ds_read_b64_tr_b16 a[222:223], v31 offset:12288
    buffer_load_dwordx4 v17, s[16:19], s27 offen offset:3072 nt lds
    v_mfma_f32_16x16x32_bf16 v[236:239], a[144:147], a[80:83], 0
    ds_read_b64_tr_b16 a[160:161], v24 offset:0
    v_exp_f32 v227, v227
    s_mov_b32 m0, s28
    v_mfma_f32_16x16x32_bf16 v[236:239], a[148:151], a[84:87], v[236:239]
    ds_read_b64_tr_b16 a[162:163], v24 offset:4096
    ds_read_b64_tr_b16 a[164:165], v24 offset:8192
    v_cvt_pk_bf16_f32 v249, v226, v227
    s_add_u32 s26, s26, 16384
    v_mfma_f32_16x16x32_bf16 v[236:239], a[152:155], a[88:91], v[236:239]
    ds_read_b64_tr_b16 a[166:167], v24 offset:12288
    v_exp_f32 v228, v228
    s_add_u32 s27, s27, 16384
    v_mfma_f32_16x16x32_bf16 v[236:239], a[156:159], a[92:95], v[236:239]
    ds_read_b64_tr_b16 a[168:169], v25 offset:0
    ds_read_b64_tr_b16 a[170:171], v25 offset:4096
    ds_read_b64_tr_b16 a[172:173], v25 offset:8192
    s_waitcnt lgkmcnt(11)
    v_mfma_f32_16x16x32_bf16 a[224:227], a[248:251], v[64:67], 0
    ds_read_b64_tr_b16 a[174:175], v25 offset:12288
    buffer_load_dwordx4 v12, s[12:15], s24 offen offset:0 nt lds
    v_exp_f32 v229, v229
    v_mfma_f32_16x16x32_bf16 a[224:227], a[248:251], v[68:71], a[224:227]
    ds_read_b64_tr_b16 a[176:177], v26 offset:0
    ds_read_b64_tr_b16 a[178:179], v26 offset:4096
    v_cvt_pk_bf16_f32 v250, v228, v229
    s_xor_b64 s[30:31], s[30:31], s[54:55]
    v_mfma_f32_16x16x32_bf16 v[48:51], a[192:195], v[64:67], 0
    ds_read_b64_tr_b16 a[180:181], v26 offset:8192
    v_exp_f32 v230, v230
    v_mfma_f32_16x16x32_bf16 v[48:51], a[196:199], v[68:71], v[48:51]
    ds_read_b64_tr_b16 a[182:183], v26 offset:12288
    ds_read_b64_tr_b16 a[184:185], v27 offset:0
    ds_read_b64_tr_b16 a[186:187], v27 offset:4096
    v_mfma_f32_16x16x32_bf16 v[52:55], a[200:203], v[64:67], 0
    ds_read_b64_tr_b16 a[188:189], v27 offset:8192
    v_exp_f32 v231, v231
    v_mfma_f32_16x16x32_bf16 v[52:55], a[204:207], v[68:71], v[52:55]
    ds_read_b64_tr_b16 a[190:191], v27 offset:12288
    buffer_load_dwordx4 v13, s[12:15], s24 offen offset:1024 nt lds
    v_cvt_pk_bf16_f32 v251, v230, v231
    v_mfma_f32_16x16x32_bf16 v[56:59], a[208:211], v[64:67], 0
    v_exp_f32 v232, v232
    s_waitcnt lgkmcnt(8)
    v_mfma_f32_16x16x32_bf16 v[56:59], a[212:215], v[68:71], v[56:59]
    v_xor_b32 v24, 0x8000, v24
    v_xor_b32 v25, 0x8000, v25
    v_mfma_f32_16x16x32_bf16 v[60:63], a[216:219], v[64:67], 0
    v_exp_f32 v233, v233
    v_mfma_f32_16x16x32_bf16 v[60:63], a[220:223], v[68:71], v[60:63]
    buffer_load_dwordx4 v14, s[12:15], s24 offen offset:2048 nt lds
    v_cvt_pk_bf16_f32 v252, v232, v233
    v_xor_b32 v26, 0x8000, v26
    v_mfma_f32_16x16x32_bf16 v[32:35], a[160:163], v[64:67], 0
    v_exp_f32 v234, v234
    v_mfma_f32_16x16x32_bf16 v[32:35], a[164:167], v[68:71], v[32:35]
    v_xor_b32 v27, 0x8000, v27
    s_waitcnt lgkmcnt(0)
    v_mfma_f32_16x16x32_bf16 v[36:39], a[168:171], v[64:67], 0
    v_exp_f32 v235, v235
    v_mfma_f32_16x16x32_bf16 v[36:39], a[172:175], v[68:71], v[36:39]
    buffer_load_dwordx4 v15, s[12:15], s24 offen offset:3072 nt lds
    v_cvt_pk_bf16_f32 v253, v234, v235
    v_xor_b32 v28, 0x8000, v28
    v_mfma_f32_16x16x32_bf16 v[40:43], a[176:179], v[64:67], 0
    v_exp_f32 v236, v236
    s_mov_b32 m0, s29
    v_mfma_f32_16x16x32_bf16 v[40:43], a[180:183], v[68:71], v[40:43]
    v_xor_b32 v29, 0x8000, v29
    v_xor_b32 v30, 0x8000, v30
    v_mfma_f32_16x16x32_bf16 v[44:47], a[184:187], v[64:67], 0
    v_exp_f32 v237, v237
    v_mfma_f32_16x16x32_bf16 v[44:47], a[188:191], v[68:71], v[44:47]
    buffer_load_dwordx4 v12, s[12:15], s25 offen offset:0 nt lds
    v_cvt_pk_bf16_f32 v254, v236, v237
    v_xor_b32 v31, 0x8000, v31
    v_mfma_f32_16x16x32_bf16 a[228:231], a[248:251], v[96:99], 0
    v_mfma_f32_16x16x32_bf16 a[228:231], a[248:251], v[100:103], a[228:231]
    v_mfma_f32_16x16x32_bf16 v[80:83], a[192:195], v[96:99], 0
    v_mfma_f32_16x16x32_bf16 v[80:83], a[196:199], v[100:103], v[80:83]
    buffer_load_dwordx4 v13, s[12:15], s25 offen offset:1024 nt lds
    v_mfma_f32_16x16x32_bf16 v[84:87], a[200:203], v[96:99], 0
    v_mfma_f32_16x16x32_bf16 v[84:87], a[204:207], v[100:103], v[84:87]
    v_mfma_f32_16x16x32_bf16 v[88:91], a[208:211], v[96:99], 0
    v_mfma_f32_16x16x32_bf16 v[88:91], a[212:215], v[100:103], v[88:91]
    buffer_load_dwordx4 v14, s[12:15], s25 offen offset:2048 nt lds
    v_mfma_f32_16x16x32_bf16 v[92:95], a[216:219], v[96:99], 0
    v_mfma_f32_16x16x32_bf16 v[92:95], a[220:223], v[100:103], v[92:95]
    v_mfma_f32_16x16x32_bf16 v[64:67], a[160:163], v[96:99], 0
    v_mfma_f32_16x16x32_bf16 v[64:67], a[164:167], v[100:103], v[64:67]
    buffer_load_dwordx4 v15, s[12:15], s25 offen offset:3072 nt lds
    s_mov_b32 m0, s30
    v_mfma_f32_16x16x32_bf16 v[68:71], a[168:171], v[96:99], 0
    s_add_u32 s24, s24, 16384
    s_add_u32 s25, s25, 16384
    v_mfma_f32_16x16x32_bf16 v[68:71], a[172:175], v[100:103], v[68:71]
    s_xor_b64 s[28:29], s[28:29], s[54:55]
    v_mfma_f32_16x16x32_bf16 v[72:75], a[176:179], v[96:99], 0
    v_mfma_f32_16x16x32_bf16 v[72:75], a[180:183], v[100:103], v[72:75]
    v_mfma_f32_16x16x32_bf16 v[76:79], a[184:187], v[96:99], 0
    v_mfma_f32_16x16x32_bf16 v[76:79], a[188:191], v[100:103], v[76:79]
    v_mfma_f32_16x16x32_bf16 a[232:235], a[248:251], v[128:131], 0
    v_mfma_f32_16x16x32_bf16 a[232:235], a[248:251], v[132:135], a[232:235]
    v_mfma_f32_16x16x32_bf16 v[112:115], a[192:195], v[128:131], 0
    v_mfma_f32_16x16x32_bf16 v[112:115], a[196:199], v[132:135], v[112:115]
    v_mfma_f32_16x16x32_bf16 v[116:119], a[200:203], v[128:131], 0
    v_mfma_f32_16x16x32_bf16 v[116:119], a[204:207], v[132:135], v[116:119]
    v_mfma_f32_16x16x32_bf16 v[120:123], a[208:211], v[128:131], 0
    v_mfma_f32_16x16x32_bf16 v[120:123], a[212:215], v[132:135], v[120:123]
    v_mfma_f32_16x16x32_bf16 v[124:127], a[216:219], v[128:131], 0
    v_mfma_f32_16x16x32_bf16 v[124:127], a[220:223], v[132:135], v[124:127]
    v_mfma_f32_16x16x32_bf16 v[96:99], a[160:163], v[128:131], 0
    v_mfma_f32_16x16x32_bf16 v[96:99], a[164:167], v[132:135], v[96:99]
    v_mfma_f32_16x16x32_bf16 v[100:103], a[168:171], v[128:131], 0
    v_mfma_f32_16x16x32_bf16 v[100:103], a[172:175], v[132:135], v[100:103]
    v_mfma_f32_16x16x32_bf16 v[104:107], a[176:179], v[128:131], 0
    v_mfma_f32_16x16x32_bf16 v[104:107], a[180:183], v[132:135], v[104:107]
    v_mfma_f32_16x16x32_bf16 v[108:111], a[184:187], v[128:131], 0
    v_mfma_f32_16x16x32_bf16 v[108:111], a[188:191], v[132:135], v[108:111]
    v_mfma_f32_16x16x32_bf16 a[236:239], a[248:251], v[160:163], 0
    v_mfma_f32_16x16x32_bf16 a[236:239], a[248:251], v[164:167], a[236:239]
    v_mfma_f32_16x16x32_bf16 v[144:147], a[192:195], v[160:163], 0
    v_mfma_f32_16x16x32_bf16 v[144:147], a[196:199], v[164:167], v[144:147]
    v_mfma_f32_16x16x32_bf16 v[148:151], a[200:203], v[160:163], 0
    v_mfma_f32_16x16x32_bf16 v[148:151], a[204:207], v[164:167], v[148:151]
    v_mfma_f32_16x16x32_bf16 v[152:155], a[208:211], v[160:163], 0
    v_mfma_f32_16x16x32_bf16 v[152:155], a[212:215], v[164:167], v[152:155]
    v_mfma_f32_16x16x32_bf16 v[156:159], a[216:219], v[160:163], 0
    v_mfma_f32_16x16x32_bf16 v[156:159], a[220:223], v[164:167], v[156:159]
    s_waitcnt vmcnt(16)
    s_barrier
    v_mfma_f32_16x16x32_bf16 v[128:131], a[160:163], v[160:163], 0
    ds_read_b128 a[96:99], v20 offset:0
    v_mfma_f32_16x16x32_bf16 v[128:131], a[164:167], v[164:167], v[128:131]
    ds_read_b128 a[100:103], v21 offset:0
    v_mfma_f32_16x16x32_bf16 v[132:135], a[168:171], v[160:163], 0
    ds_read_b128 a[104:107], v22 offset:0
    v_mfma_f32_16x16x32_bf16 v[132:135], a[172:175], v[164:167], v[132:135]
    ds_read_b128 a[108:111], v23 offset:0
    v_mfma_f32_16x16x32_bf16 v[136:139], a[176:179], v[160:163], 0
    ds_read_b128 a[112:115], v20 offset:4096
    v_mfma_f32_16x16x32_bf16 v[136:139], a[180:183], v[164:167], v[136:139]
    ds_read_b128 a[116:119], v21 offset:4096
    v_mfma_f32_16x16x32_bf16 v[140:143], a[184:187], v[160:163], 0
    ds_read_b128 a[120:123], v22 offset:4096
    v_mfma_f32_16x16x32_bf16 v[140:143], a[188:191], v[164:167], v[140:143]
    ds_read_b128 a[124:127], v23 offset:4096
    v_mfma_f32_16x16x32_bf16 a[240:243], a[248:251], v[240:243], 0
    ds_read_b128 a[128:131], v20 offset:8192
    v_mfma_f32_16x16x32_bf16 a[240:243], a[248:251], v[244:247], a[240:243]
    ds_read_b128 a[132:135], v21 offset:8192
    v_mfma_f32_16x16x32_bf16 v[176:179], a[192:195], v[240:243], 0
    ds_read_b128 a[136:139], v22 offset:8192
    v_mfma_f32_16x16x32_bf16 v[176:179], a[196:199], v[244:247], v[176:179]
    ds_read_b128 a[140:143], v23 offset:8192
    v_mfma_f32_16x16x32_bf16 v[180:183], a[200:203], v[240:243], 0
    ds_read_b128 a[144:147], v20 offset:12288
    v_mfma_f32_16x16x32_bf16 v[180:183], a[204:207], v[244:247], v[180:183]
    ds_read_b128 a[148:151], v21 offset:12288
    v_mfma_f32_16x16x32_bf16 v[184:187], a[208:211], v[240:243], 0
    ds_read_b128 a[152:155], v22 offset:12288
    v_mfma_f32_16x16x32_bf16 v[184:187], a[212:215], v[244:247], v[184:187]
    ds_read_b128 a[156:159], v23 offset:12288
    v_xor_b32 v20, 0x8000, v20
    v_mfma_f32_16x16x32_bf16 v[188:191], a[216:219], v[240:243], 0
    v_xor_b32 v21, 0x8000, v21
    v_xor_b32 v22, 0x8000, v22
    v_mfma_f32_16x16x32_bf16 v[188:191], a[220:223], v[244:247], v[188:191]
    v_xor_b32 v23, 0x8000, v23
    v_mfma_f32_16x16x32_bf16 v[160:163], a[160:163], v[240:243], 0
    v_mfma_f32_16x16x32_bf16 v[160:163], a[164:167], v[244:247], v[160:163]
    v_mfma_f32_16x16x32_bf16 v[164:167], a[168:171], v[240:243], 0
    v_mfma_f32_16x16x32_bf16 v[164:167], a[172:175], v[244:247], v[164:167]
    s_waitcnt lgkmcnt(0)
    v_mfma_f32_16x16x32_bf16 v[168:171], a[176:179], v[240:243], 0
    v_mfma_f32_16x16x32_bf16 v[168:171], a[180:183], v[244:247], v[168:171]
    v_mfma_f32_16x16x32_bf16 v[172:175], a[184:187], v[240:243], 0
    v_mfma_f32_16x16x32_bf16 v[172:175], a[188:191], v[244:247], v[172:175]
    s_branch L_pg2
L_flag:
    buffer_atomic_or v18, v19, s[44:47], 0 offen sc1
    s_branch L_flag_ret
.p2align 12
L_pg2:
    s_cbranch_execz L_back
L_loop:
    v_mfma_f32_16x16x32_bf16 v[224:227], a[96:99], a[0:3], 0
    v_exp_f32 v238, v238
    v_mfma_f32_16x16x32_bf16 v[224:227], a[100:103], a[4:7], v[224:227]
    buffer_load_dwordx4 v16, s[16:19], s26 offen offset:0 nt lds
    v_mfma_f32_16x16x32_bf16 v[224:227], a[104:107], a[8:11], v[224:227]
    v_exp_f32 v239, v239
    v_mfma_f32_16x16x32_bf16 v[224:227], a[108:111], a[12:15], v[224:227]
    v_cvt_pk_bf16_f32 v255, v238, v239
    v_mfma_f32_16x16x32_bf16 v[228:231], a[112:115], a[0:3], 0
    buffer_load_dwordx4 v17, s[16:19], s26 offen offset:1024 nt lds
    v_mfma_f32_16x16x32_bf16 v[228:231], a[116:119], a[4:7], v[228:231]
    v_mfma_f32_16x16x32_bf16 v[228:231], a[120:123], a[8:11], v[228:231]
    v_exp_f32 v224, v224
    v_mfma_f32_16x16x32_bf16 v[228:231], a[124:127], a[12:15], v[228:231]
    buffer_load_dwordx4 v16, s[16:19], s26 offen offset:2048 nt lds
    v_mfma_f32_16x16x32_bf16 v[232:235], a[128:131], a[0:3], 0
    v_exp_f32 v225, v225
    v_mfma_f32_16x16x32_bf16 v[232:235], a[132:135], a[4:7], v[232:235]
    v_cvt_pk_bf16_f32 v240, v224, v225
    v_mfma_f32_16x16x32_bf16 v[232:235], a[136:139], a[8:11], v[232:235]
    v_exp_f32 v226, v226
    v_mfma_f32_16x16x32_bf16 v[232:235], a[140:143], a[12:15], v[232:235]
    buffer_load_dwordx4 v17, s[16:19], s26 offen offset:3072 nt lds
    v_mfma_f32_16x16x32_bf16 v[236:239], a[144:147], a[0:3], 0
    v_exp_f32 v227, v227
    v_mfma_f32_16x16x32_bf16 v[236:239], a[148:151], a[4:7], v[236:239]
    v_cvt_pk_bf16_f32 v241, v226, v227
    s_mov_b32 m0, s31
    v_mfma_f32_16x16x32_bf16 v[236:239], a[152:155], a[8:11], v[236:239]
    v_exp_f32 v228, v228
    v_mfma_f32_16x16x32_bf16 v[236:239], a[156:159], a[12:15], v[236:239]
    buffer_load_dwordx4 v16, s[16:19], s27 offen offset:0 nt lds
    v_mfma_f32_16x16x32_bf16 a[244:247], a[248:251], v[248:251], a[244:247]
    v_exp_f32 v229, v229
    v_mfma_f32_16x16x32_bf16 a[244:247], a[248:251], v[252:255], a[244:247]
    v_cvt_pk_bf16_f32 v242, v228, v229
    v_mfma_f32_16x16x32_bf16 v[208:211], a[192:195], v[248:251], v[208:211]
    v_exp_f32 v230, v230
    v_mfma_f32_16x16x32_bf16 v[208:211], a[196:199], v[252:255], v[208:211]
    buffer_load_dwordx4 v17, s[16:19], s27 offen offset:1024 nt lds
    v_mfma_f32_16x16x32_bf16 v[212:215], a[200:203], v[248:251], v[212:215]
    v_exp_f32 v231, v231
    v_mfma_f32_16x16x32_bf16 v[212:215], a[204:207], v[252:255], v[212:215]
    buffer_load_dwordx4 v16, s[16:19], s27 offen offset:2048 nt lds
    v_cvt_pk_bf16_f32 v243, v230, v231
    v_mfma_f32_16x16x32_bf16 v[216:219], a[208:211], v[248:251], v[216:219]
    v_exp_f32 v232, v232
    v_mfma_f32_16x16x32_bf16 v[216:219], a[212:215], v[252:255], v[216:219]
    buffer_load_dwordx4 v17, s[16:19], s27 offen offset:3072 nt lds
    s_waitcnt vmcnt(16)
    s_barrier
    v_mfma_f32_16x16x32_bf16 v[220:223], a[216:219], v[248:251], v[220:223]
    v_exp_f32 v233, v233
    s_add_u32 s26, s26, 16384
    v_mfma_f32_16x16x32_bf16 v[220:223], a[220:223], v[252:255], v[220:223]
    ds_read_b64_tr_b16 a[192:193], v28 offset:0
    v_cvt_pk_bf16_f32 v244, v232, v233
    s_add_u32 s27, s27, 16384
    v_mfma_f32_16x16x32_bf16 v[192:195], a[160:163], v[248:251], v[192:195]
    v_exp_f32 v234, v234
    s_xor_b64 s[30:31], s[30:31], s[54:55]
    v_mfma_f32_16x16x32_bf16 v[192:195], a[164:167], v[252:255], v[192:195]
    ds_read_b64_tr_b16 a[194:195], v28 offset:4096
    ds_read_b64_tr_b16 a[196:197], v28 offset:8192
    v_mfma_f32_16x16x32_bf16 v[196:199], a[168:171], v[248:251], v[196:199]
    v_exp_f32 v235, v235
    v_mfma_f32_16x16x32_bf16 v[196:199], a[172:175], v[252:255], v[196:199]
    ds_read_b64_tr_b16 a[198:199], v28 offset:12288
    v_cvt_pk_bf16_f32 v245, v234, v235
    v_mfma_f32_16x16x32_bf16 v[200:203], a[176:179], v[248:251], v[200:203]
    v_exp_f32 v236, v236
    v_mfma_f32_16x16x32_bf16 v[200:203], a[180:183], v[252:255], v[200:203]
    ds_read_b64_tr_b16 a[200:201], v29 offset:0
    ds_read_b64_tr_b16 a[202:203], v29 offset:4096
    v_mfma_f32_16x16x32_bf16 v[204:207], a[184:187], v[248:251], v[204:207]
    v_exp_f32 v237, v237
    v_mfma_f32_16x16x32_bf16 v[204:207], a[188:191], v[252:255], v[204:207]
    ds_read_b64_tr_b16 a[204:205], v29 offset:8192
    v_cvt_pk_bf16_f32 v246, v236, v237
    v_mfma_f32_16x16x32_bf16 v[224:227], a[96:99], a[16:19], 0
    v_exp_f32 v238, v238
    v_mfma_f32_16x16x32_bf16 v[224:227], a[100:103], a[20:23], v[224:227]
    ds_read_b64_tr_b16 a[206:207], v29 offset:12288
    ds_read_b64_tr_b16 a[208:209], v30 offset:0
    v_mfma_f32_16x16x32_bf16 v[224:227], a[104:107], a[24:27], v[224:227]
    v_exp_f32 v239, v239
    v_mfma_f32_16x16x32_bf16 v[224:227], a[108:111], a[28:31], v[224:227]
    ds_read_b64_tr_b16 a[210:211], v30 offset:4096
    v_cvt_pk_bf16_f32 v247, v238, v239
    v_mfma_f32_16x16x32_bf16 v[228:231], a[112:115], a[16:19], 0
    ds_read_b64_tr_b16 a[212:213], v30 offset:8192
    ds_read_b64_tr_b16 a[214:215], v30 offset:12288
    v_mfma_f32_16x16x32_bf16 v[228:231], a[116:119], a[20:23], v[228:231]
    ds_read_b64_tr_b16 a[216:217], v31 offset:0
    ds_read_b64_tr_b16 a[218:219], v31 offset:4096
    v_mfma_f32_16x16x32_bf16 v[228:231], a[120:123], a[24:27], v[228:231]
    v_exp_f32 v224, v224
    v_mfma_f32_16x16x32_bf16 v[228:231], a[124:127], a[28:31], v[228:231]
    ds_read_b64_tr_b16 a[220:221], v31 offset:8192
    ds_read_b64_tr_b16 a[222:223], v31 offset:12288
    v_mfma_f32_16x16x32_bf16 v[232:235], a[128:131], a[16:19], 0
    v_exp_f32 v225, v225
    v_mfma_f32_16x16x32_bf16 v[232:235], a[132:135], a[20:23], v[232:235]
    ds_read_b64_tr_b16 a[160:161], v24 offset:0
    v_cvt_pk_bf16_f32 v248, v224, v225
    v_mfma_f32_16x16x32_bf16 v[232:235], a[136:139], a[24:27], v[232:235]
    v_exp_f32 v226, v226
    v_mfma_f32_16x16x32_bf16 v[232:235], a[140:143], a[28:31], v[232:235]
    ds_read_b64_tr_b16 a[162:163], v24 offset:4096
    ds_read_b64_tr_b16 a[164:165], v24 offset:8192
    v_mfma_f32_16x16x32_bf16 v[236:239], a[144:147], a[16:19], 0
    v_exp_f32 v227, v227
    v_mfma_f32_16x16x32_bf16 v[236:239], a[148:151], a[20:23], v[236:239]
    ds_read_b64_tr_b16 a[166:167], v24 offset:12288
    v_cvt_pk_bf16_f32 v249, v226, v227
    v_mfma_f32_16x16x32_bf16 v[236:239], a[152:155], a[24:27], v[236:239]
    v_exp_f32 v228, v228
    s_waitcnt lgkmcnt(8)
    v_mfma_f32_16x16x32_bf16 v[236:239], a[156:159], a[28:31], v[236:239]
    ds_read_b64_tr_b16 a[168:169], v25 offset:0
    ds_read_b64_tr_b16 a[170:171], v25 offset:4096
    v_mfma_f32_16x16x32_bf16 a[224:227], a[248:251], v[240:243], a[224:227]
    v_exp_f32 v229, v229
    v_mfma_f32_16x16x32_bf16 a[224:227], a[248:251], v[244:247], a[224:227]
    ds_read_b64_tr_b16 a[172:173], v25 offset:8192
    v_cvt_pk_bf16_f32 v250, v228, v229
    v_mfma_f32_16x16x32_bf16 v[48:51], a[192:195], v[240:243], v[48:51]
    v_exp_f32 v230, v230
    v_mfma_f32_16x16x32_bf16 v[48:51], a[196:199], v[244:247], v[48:51]
    ds_read_b64_tr_b16 a[174:175], v25 offset:12288
    ds_read_b64_tr_b16 a[176:177], v26 offset:0
    v_mfma_f32_16x16x32_bf16 v[52:55], a[200:203], v[240:243], v[52:55]
    v_exp_f32 v231, v231
    v_mfma_f32_16x16x32_bf16 v[52:55], a[204:207], v[244:247], v[52:55]
    ds_read_b64_tr_b16 a[178:179], v26 offset:4096
    v_cvt_pk_bf16_f32 v251, v230, v231
    v_mfma_f32_16x16x32_bf16 v[56:59], a[208:211], v[240:243], v[56:59]
    v_exp_f32 v232, v232
    v_mfma_f32_16x16x32_bf16 v[56:59], a[212:215], v[244:247], v[56:59]
    ds_read_b64_tr_b16 a[180:181], v26 offset:8192
    ds_read_b64_tr_b16 a[182:183], v26 offset:12288
    ds_read_b64_tr_b16 a[184:185], v27 offset:0
    s_waitcnt lgkmcnt(5)
    v_mfma_f32_16x16x32_bf16 v[60:63], a[216:219], v[240:243], v[60:63]
    ds_read_b64_tr_b16 a[186:187], v27 offset:4096
    v_exp_f32 v233, v233
    v_mfma_f32_16x16x32_bf16 v[60:63], a[220:223], v[244:247], v[60:63]
    ds_read_b64_tr_b16 a[188:189], v27 offset:8192
    ds_read_b64_tr_b16 a[190:191], v27 offset:12288
    v_cvt_pk_bf16_f32 v252, v232, v233
    v_mfma_f32_16x16x32_bf16 v[32:35], a[160:163], v[240:243], v[32:35]
    v_exp_f32 v234, v234
    v_mfma_f32_16x16x32_bf16 v[32:35], a[164:167], v[244:247], v[32:35]
    v_xor_b32 v24, 0x8000, v24
    v_xor_b32 v25, 0x8000, v25
    v_mfma_f32_16x16x32_bf16 v[36:39], a[168:171], v[240:243], v[36:39]
    v_exp_f32 v235, v235
    v_mfma_f32_16x16x32_bf16 v[36:39], a[172:175], v[244:247], v[36:39]
    v_cvt_pk_bf16_f32 v253, v234, v235
    s_waitcnt lgkmcnt(0)
    v_mfma_f32_16x16x32_bf16 v[40:43], a[176:179], v[240:243], v[40:43]
    v_exp_f32 v236, v236
    v_mfma_f32_16x16x32_bf16 v[40:43], a[180:183], v[244:247], v[40:43]
    v_xor_b32 v26, 0x8000, v26
    v_xor_b32 v27, 0x8000, v27
    v_mfma_f32_16x16x32_bf16 v[44:47], a[184:187], v[240:243], v[44:47]
    v_exp_f32 v237, v237
    v_mfma_f32_16x16x32_bf16 v[44:47], a[188:191], v[244:247], v[44:47]
    v_cvt_pk_bf16_f32 v254, v236, v237
    v_xor_b32 v28, 0x8000, v28
    v_mfma_f32_16x16x32_bf16 v[224:227], a[96:99], a[32:35], 0
    v_exp_f32 v238, v238
    v_mfma_f32_16x16x32_bf16 v[224:227], a[100:103], a[36:39], v[224:227]
    v_xor_b32 v29, 0x8000, v29
    v_xor_b32 v30, 0x8000, v30
    v_mfma_f32_16x16x32_bf16 v[224:227], a[104:107], a[40:43], v[224:227]
    v_exp_f32 v239, v239
    v_mfma_f32_16x16x32_bf16 v[224:227], a[108:111], a[44:47], v[224:227]
    v_cvt_pk_bf16_f32 v255, v238, v239
    v_xor_b32 v31, 0x8000, v31
    v_mfma_f32_16x16x32_bf16 v[228:231], a[112:115], a[32:35], 0
    s_mov_b32 m0, s28
    v_mfma_f32_16x16x32_bf16 v[228:231], a[116:119], a[36:39], v[228:231]
    buffer_store_dwordx4 a[252:255], v4, s[8:11], s63 offen sc0 sc1
    v_mfma_f32_16x16x32_bf16 v[228:231], a[120:123], a[40:43], v[228:231]
    v_exp_f32 v224, v224
    v_mfma_f32_16x16x32_bf16 v[228:231], a[124:127], a[44:47], v[228:231]
    s_add_u32 s63, s63, 1048576
    v_mfma_f32_16x16x32_bf16 v[232:235], a[128:131], a[32:35], 0
    v_exp_f32 v225, v225
    v_mfma_f32_16x16x32_bf16 v[232:235], a[132:135], a[36:39], v[232:235]
    v_cvt_pk_bf16_f32 v240, v224, v225
    v_mfma_f32_16x16x32_bf16 v[232:235], a[136:139], a[40:43], v[232:235]
    v_exp_f32 v226, v226
    v_mfma_f32_16x16x32_bf16 v[232:235], a[140:143], a[44:47], v[232:235]
    v_mfma_f32_16x16x32_bf16 v[236:239], a[144:147], a[32:35], 0
    v_exp_f32 v227, v227
    v_mfma_f32_16x16x32_bf16 v[236:239], a[148:151], a[36:39], v[236:239]
    v_cvt_pk_bf16_f32 v241, v226, v227
    v_mfma_f32_16x16x32_bf16 v[236:239], a[152:155], a[40:43], v[236:239]
    v_exp_f32 v228, v228
    v_mfma_f32_16x16x32_bf16 v[236:239], a[156:159], a[44:47], v[236:239]
    v_mfma_f32_16x16x32_bf16 a[228:231], a[248:251], v[248:251], a[228:231]
    v_exp_f32 v229, v229
    v_mfma_f32_16x16x32_bf16 a[228:231], a[248:251], v[252:255], a[228:231]
    v_cvt_pk_bf16_f32 v242, v228, v229
    v_mfma_f32_16x16x32_bf16 v[80:83], a[192:195], v[248:251], v[80:83]
    v_exp_f32 v230, v230
    v_mfma_f32_16x16x32_bf16 v[80:83], a[196:199], v[252:255], v[80:83]
    buffer_store_dwordx4 a[252:255], v4, s[8:11], s63 offen sc0 sc1
    v_mfma_f32_16x16x32_bf16 v[84:87], a[200:203], v[248:251], v[84:87]
    v_exp_f32 v231, v231
    v_mfma_f32_16x16x32_bf16 v[84:87], a[204:207], v[252:255], v[84:87]
    v_cvt_pk_bf16_f32 v243, v230, v231
    s_add_u32 s63, s63, 1048576
    v_mfma_f32_16x16x32_bf16 v[88:91], a[208:211], v[248:251], v[88:91]
    v_exp_f32 v232, v232
    v_mfma_f32_16x16x32_bf16 v[88:91], a[212:215], v[252:255], v[88:91]
    v_mfma_f32_16x16x32_bf16 v[92:95], a[216:219], v[248:251], v[92:95]
    v_exp_f32 v233, v233
    v_mfma_f32_16x16x32_bf16 v[92:95], a[220:223], v[252:255], v[92:95]
    v_cvt_pk_bf16_f32 v244, v232, v233
    v_mfma_f32_16x16x32_bf16 v[64:67], a[160:163], v[248:251], v[64:67]
    v_exp_f32 v234, v234
    v_mfma_f32_16x16x32_bf16 v[64:67], a[164:167], v[252:255], v[64:67]
    v_mfma_f32_16x16x32_bf16 v[68:71], a[168:171], v[248:251], v[68:71]
    v_exp_f32 v235, v235
    v_mfma_f32_16x16x32_bf16 v[68:71], a[172:175], v[252:255], v[68:71]
    v_cvt_pk_bf16_f32 v245, v234, v235
    v_mfma_f32_16x16x32_bf16 v[72:75], a[176:179], v[248:251], v[72:75]
    v_exp_f32 v236, v236
    v_mfma_f32_16x16x32_bf16 v[72:75], a[180:183], v[252:255], v[72:75]
    v_mfma_f32_16x16x32_bf16 v[76:79], a[184:187], v[248:251], v[76:79]
    v_exp_f32 v237, v237
    v_mfma_f32_16x16x32_bf16 v[76:79], a[188:191], v[252:255], v[76:79]
    v_cvt_pk_bf16_f32 v246, v236, v237
    v_mfma_f32_16x16x32_bf16 v[224:227], a[96:99], a[48:51], 0
    v_exp_f32 v238, v238
    v_mfma_f32_16x16x32_bf16 v[224:227], a[100:103], a[52:55], v[224:227]
    buffer_load_dwordx4 v12, s[12:15], s24 offen offset:0 nt lds
    v_mfma_f32_16x16x32_bf16 v[224:227], a[104:107], a[56:59], v[224:227]
    v_exp_f32 v239, v239
    v_mfma_f32_16x16x32_bf16 v[224:227], a[108:111], a[60:63], v[224:227]
    v_cvt_pk_bf16_f32 v247, v238, v239
    v_mfma_f32_16x16x32_bf16 v[228:231], a[112:115], a[48:51], 0
    buffer_load_dwordx4 v13, s[12:15], s24 offen offset:1024 nt lds
    v_mfma_f32_16x16x32_bf16 v[228:231], a[116:119], a[52:55], v[228:231]
    v_mfma_f32_16x16x32_bf16 v[228:231], a[120:123], a[56:59], v[228:231]
    v_exp_f32 v224, v224
    v_mfma_f32_16x16x32_bf16 v[228:231], a[124:127], a[60:63], v[228:231]
    buffer_load_dwordx4 v14, s[12:15], s24 offen offset:2048 nt lds
    v_mfma_f32_16x16x32_bf16 v[232:235], a[128:131], a[48:51], 0
    v_exp_f32 v225, v225
    v_mfma_f32_16x16x32_bf16 v[232:235], a[132:135], a[52:55], v[232:235]
    v_cvt_pk_bf16_f32 v248, v224, v225
    v_mfma_f32_16x16x32_bf16 v[232:235], a[136:139], a[56:59], v[232:235]
    v_exp_f32 v226, v226
    v_mfma_f32_16x16x32_bf16 v[232:235], a[140:143], a[60:63], v[232:235]
    buffer_load_dwordx4 v15, s[12:15], s24 offen offset:3072 nt lds
    v_mfma_f32_16x16x32_bf16 v[236:239], a[144:147], a[48:51], 0
    v_exp_f32 v227, v227
    v_mfma_f32_16x16x32_bf16 v[236:239], a[148:151], a[52:55], v[236:239]
    v_cvt_pk_bf16_f32 v249, v226, v227
    s_mov_b32 m0, s29
    v_mfma_f32_16x16x32_bf16 v[236:239], a[152:155], a[56:59], v[236:239]
    v_exp_f32 v228, v228
    v_mfma_f32_16x16x32_bf16 v[236:239], a[156:159], a[60:63], v[236:239]
    buffer_load_dwordx4 v12, s[12:15], s25 offen offset:0 nt lds
    v_mfma_f32_16x16x32_bf16 a[232:235], a[248:251], v[240:243], a[232:235]
    v_exp_f32 v229, v229
    v_mfma_f32_16x16x32_bf16 a[232:235], a[248:251], v[244:247], a[232:235]
    v_cvt_pk_bf16_f32 v250, v228, v229
    v_mfma_f32_16x16x32_bf16 v[112:115], a[192:195], v[240:243], v[112:115]
    v_exp_f32 v230, v230
    v_mfma_f32_16x16x32_bf16 v[112:115], a[196:199], v[244:247], v[112:115]
    buffer_load_dwordx4 v13, s[12:15], s25 offen offset:1024 nt lds
    v_mfma_f32_16x16x32_bf16 v[116:119], a[200:203], v[240:243], v[116:119]
    v_exp_f32 v231, v231
    v_mfma_f32_16x16x32_bf16 v[116:119], a[204:207], v[244:247], v[116:119]
    v_cvt_pk_bf16_f32 v251, v230, v231
    v_mfma_f32_16x16x32_bf16 v[120:123], a[208:211], v[240:243], v[120:123]
    v_exp_f32 v232, v232
    v_mfma_f32_16x16x32_bf16 v[120:123], a[212:215], v[244:247], v[120:123]
    buffer_load_dwordx4 v14, s[12:15], s25 offen offset:2048 nt lds
    v_mfma_f32_16x16x32_bf16 v[124:127], a[216:219], v[240:243], v[124:127]
    v_exp_f32 v233, v233
    v_mfma_f32_16x16x32_bf16 v[124:127], a[220:223], v[244:247], v[124:127]
    v_cvt_pk_bf16_f32 v252, v232, v233
    v_mfma_f32_16x16x32_bf16 v[96:99], a[160:163], v[240:243], v[96:99]
    v_exp_f32 v234, v234
    v_mfma_f32_16x16x32_bf16 v[96:99], a[164:167], v[244:247], v[96:99]
    buffer_load_dwordx4 v15, s[12:15], s25 offen offset:3072 nt lds
    s_add_u32 s24, s24, 16384
    v_mfma_f32_16x16x32_bf16 v[100:103], a[168:171], v[240:243], v[100:103]
    v_exp_f32 v235, v235
    s_add_u32 s25, s25, 16384
    v_mfma_f32_16x16x32_bf16 v[100:103], a[172:175], v[244:247], v[100:103]
    v_cvt_pk_bf16_f32 v253, v234, v235
    s_mov_b32 m0, s30
    v_mfma_f32_16x16x32_bf16 v[104:107], a[176:179], v[240:243], v[104:107]
    v_exp_f32 v236, v236
    v_mfma_f32_16x16x32_bf16 v[104:107], a[180:183], v[244:247], v[104:107]
    s_xor_b64 s[28:29], s[28:29], s[54:55]
    v_mfma_f32_16x16x32_bf16 v[108:111], a[184:187], v[240:243], v[108:111]
    v_exp_f32 v237, v237
    v_mfma_f32_16x16x32_bf16 v[108:111], a[188:191], v[244:247], v[108:111]
    v_cvt_pk_bf16_f32 v254, v236, v237
    v_mfma_f32_16x16x32_bf16 v[224:227], a[96:99], a[64:67], 0
    v_exp_f32 v238, v238
    v_mfma_f32_16x16x32_bf16 v[224:227], a[100:103], a[68:71], v[224:227]
    s_add_u32 s38, s38, 1
    v_mfma_f32_16x16x32_bf16 v[224:227], a[104:107], a[72:75], v[224:227]
    v_exp_f32 v239, v239
    v_mfma_f32_16x16x32_bf16 v[224:227], a[108:111], a[76:79], v[224:227]
    v_cvt_pk_bf16_f32 v255, v238, v239
    v_mfma_f32_16x16x32_bf16 v[228:231], a[112:115], a[64:67], 0
    v_mfma_f32_16x16x32_bf16 v[228:231], a[116:119], a[68:71], v[228:231]
    v_mfma_f32_16x16x32_bf16 v[228:231], a[120:123], a[72:75], v[228:231]
    v_exp_f32 v224, v224
    v_mfma_f32_16x16x32_bf16 v[228:231], a[124:127], a[76:79], v[228:231]
    v_mfma_f32_16x16x32_bf16 v[232:235], a[128:131], a[64:67], 0
    v_exp_f32 v225, v225
    v_mfma_f32_16x16x32_bf16 v[232:235], a[132:135], a[68:71], v[232:235]
    v_cvt_pk_bf16_f32 v240, v224, v225
    v_mfma_f32_16x16x32_bf16 v[232:235], a[136:139], a[72:75], v[232:235]
    v_exp_f32 v226, v226
    v_mfma_f32_16x16x32_bf16 v[232:235], a[140:143], a[76:79], v[232:235]
    v_mfma_f32_16x16x32_bf16 v[236:239], a[144:147], a[64:67], 0
    v_exp_f32 v227, v227
    v_mfma_f32_16x16x32_bf16 v[236:239], a[148:151], a[68:71], v[236:239]
    v_cvt_pk_bf16_f32 v241, v226, v227
    v_mfma_f32_16x16x32_bf16 v[236:239], a[152:155], a[72:75], v[236:239]
    v_exp_f32 v228, v228
    v_mfma_f32_16x16x32_bf16 v[236:239], a[156:159], a[76:79], v[236:239]
    buffer_store_dword a252, v5, s[8:11], s63 offen sc0 sc1
    v_mfma_f32_16x16x32_bf16 a[236:239], a[248:251], v[248:251], a[236:239]
    v_exp_f32 v229, v229
    v_mfma_f32_16x16x32_bf16 a[236:239], a[248:251], v[252:255], a[236:239]
    v_cvt_pk_bf16_f32 v242, v228, v229
    s_add_u32 s63, s63, 1048576
    v_mfma_f32_16x16x32_bf16 v[144:147], a[192:195], v[248:251], v[144:147]
    v_exp_f32 v230, v230
    v_mfma_f32_16x16x32_bf16 v[144:147], a[196:199], v[252:255], v[144:147]
    v_mfma_f32_16x16x32_bf16 v[148:151], a[200:203], v[248:251], v[148:151]
    v_exp_f32 v231, v231
    v_mfma_f32_16x16x32_bf16 v[148:151], a[204:207], v[252:255], v[148:151]
    v_cvt_pk_bf16_f32 v243, v230, v231
    v_mfma_f32_16x16x32_bf16 v[152:155], a[208:211], v[248:251], v[152:155]
    v_exp_f32 v232, v232
    v_mfma_f32_16x16x32_bf16 v[152:155], a[212:215], v[252:255], v[152:155]
    v_mfma_f32_16x16x32_bf16 v[156:159], a[216:219], v[248:251], v[156:159]
    v_exp_f32 v233, v233
    v_mfma_f32_16x16x32_bf16 v[156:159], a[220:223], v[252:255], v[156:159]
    v_cvt_pk_bf16_f32 v244, v232, v233
    v_mfma_f32_16x16x32_bf16 v[128:131], a[160:163], v[248:251], v[128:131]
    v_exp_f32 v234, v234
    v_mfma_f32_16x16x32_bf16 v[128:131], a[164:167], v[252:255], v[128:131]
    v_mfma_f32_16x16x32_bf16 v[132:135], a[168:171], v[248:251], v[132:135]
    v_exp_f32 v235, v235
    v_mfma_f32_16x16x32_bf16 v[132:135], a[172:175], v[252:255], v[132:135]
    v_cvt_pk_bf16_f32 v245, v234, v235
    v_mfma_f32_16x16x32_bf16 v[136:139], a[176:179], v[248:251], v[136:139]
    v_exp_f32 v236, v236
    v_mfma_f32_16x16x32_bf16 v[136:139], a[180:183], v[252:255], v[136:139]
    v_mfma_f32_16x16x32_bf16 v[140:143], a[184:187], v[248:251], v[140:143]
    v_exp_f32 v237, v237
    v_mfma_f32_16x16x32_bf16 v[140:143], a[188:191], v[252:255], v[140:143]
    v_cvt_pk_bf16_f32 v246, v236, v237
    s_waitcnt vmcnt(19)
    s_barrier
    v_mfma_f32_16x16x32_bf16 v[224:227], a[96:99], a[80:83], 0
    v_exp_f32 v238, v238
    v_mfma_f32_16x16x32_bf16 v[224:227], a[100:103], a[84:87], v[224:227]
    ds_read_b128 a[96:99], v20 offset:0
    ds_read_b128 a[100:103], v21 offset:0
    v_mfma_f32_16x16x32_bf16 v[224:227], a[104:107], a[88:91], v[224:227]
    v_exp_f32 v239, v239
    v_mfma_f32_16x16x32_bf16 v[224:227], a[108:111], a[92:95], v[224:227]
    ds_read_b128 a[104:107], v22 offset:0
    v_cvt_pk_bf16_f32 v247, v238, v239
    v_mfma_f32_16x16x32_bf16 v[228:231], a[112:115], a[80:83], 0
    ds_read_b128 a[108:111], v23 offset:0
    ds_read_b128 a[112:115], v20 offset:4096
    v_mfma_f32_16x16x32_bf16 v[228:231], a[116:119], a[84:87], v[228:231]
    ds_read_b128 a[116:119], v21 offset:4096
    v_mfma_f32_16x16x32_bf16 v[228:231], a[120:123], a[88:91], v[228:231]
    v_exp_f32 v224, v224
    v_mfma_f32_16x16x32_bf16 v[228:231], a[124:127], a[92:95], v[228:231]
    ds_read_b128 a[120:123], v22 offset:4096
    ds_read_b128 a[124:127], v23 offset:4096
    v_mfma_f32_16x16x32_bf16 v[232:235], a[128:131], a[80:83], 0
    v_exp_f32 v225, v225
    v_mfma_f32_16x16x32_bf16 v[232:235], a[132:135], a[84:87], v[232:235]
    ds_read_b128 a[128:131], v20 offset:8192
    v_cvt_pk_bf16_f32 v248, v224, v225
    v_mfma_f32_16x16x32_bf16 v[232:235], a[136:139], a[88:91], v[232:235]
    v_exp_f32 v226, v226
    v_mfma_f32_16x16x32_bf16 v[232:235], a[140:143], a[92:95], v[232:235]
    ds_read_b128 a[132:135], v21 offset:8192
    ds_read_b128 a[136:139], v22 offset:8192
    v_mfma_f32_16x16x32_bf16 v[236:239], a[144:147], a[80:83], 0
    v_exp_f32 v227, v227
    v_mfma_f32_16x16x32_bf16 v[236:239], a[148:151], a[84:87], v[236:239]
    ds_read_b128 a[140:143], v23 offset:8192
    v_cvt_pk_bf16_f32 v249, v226, v227
    v_mfma_f32_16x16x32_bf16 v[236:239], a[152:155], a[88:91], v[236:239]
    v_exp_f32 v228, v228
    v_mfma_f32_16x16x32_bf16 v[236:239], a[156:159], a[92:95], v[236:239]
    ds_read_b128 a[144:147], v20 offset:12288
    ds_read_b128 a[148:151], v21 offset:12288
    v_mfma_f32_16x16x32_bf16 a[240:243], a[248:251], v[240:243], a[240:243]
    v_exp_f32 v229, v229
    v_mfma_f32_16x16x32_bf16 a[240:243], a[248:251], v[244:247], a[240:243]
    ds_read_b128 a[152:155], v22 offset:12288
    v_cvt_pk_bf16_f32 v250, v228, v229
    v_mfma_f32_16x16x32_bf16 v[176:179], a[192:195], v[240:243], v[176:179]
    v_exp_f32 v230, v230
    v_mfma_f32_16x16x32_bf16 v[176:179], a[196:199], v[244:247], v[176:179]
    ds_read_b128 a[156:159], v23 offset:12288
    v_xor_b32 v20, 0x8000, v20
    v_mfma_f32_16x16x32_bf16 v[180:183], a[200:203], v[240:243], v[180:183]
    v_exp_f32 v231, v231
    v_mfma_f32_16x16x32_bf16 v[180:183], a[204:207], v[244:247], v[180:183]
    v_cvt_pk_bf16_f32 v251, v230, v231
    v_xor_b32 v21, 0x8000, v21
    v_mfma_f32_16x16x32_bf16 v[184:187], a[208:211], v[240:243], v[184:187]
    v_exp_f32 v232, v232
    v_mfma_f32_16x16x32_bf16 v[184:187], a[212:215], v[244:247], v[184:187]
    v_xor_b32 v22, 0x8000, v22
    v_xor_b32 v23, 0x8000, v23
    v_mfma_f32_16x16x32_bf16 v[188:191], a[216:219], v[240:243], v[188:191]
    v_exp_f32 v233, v233
    v_mfma_f32_16x16x32_bf16 v[188:191], a[220:223], v[244:247], v[188:191]
    v_cvt_pk_bf16_f32 v252, v232, v233
    s_waitcnt lgkmcnt(0)
    v_mfma_f32_16x16x32_bf16 v[160:163], a[160:163], v[240:243], v[160:163]
    v_exp_f32 v234, v234
    v_mfma_f32_16x16x32_bf16 v[160:163], a[164:167], v[244:247], v[160:163]
    s_cmp_eq_u32 s38, s39
    s_cbranch_scc1 L_flag
L_flag_ret:
    v_mfma_f32_16x16x32_bf16 v[164:167], a[168:171], v[240:243], v[164:167]
    v_exp_f32 v235, v235
    v_mfma_f32_16x16x32_bf16 v[164:167], a[172:175], v[244:247], v[164:167]
    v_cvt_pk_bf16_f32 v253, v234, v235
    v_mfma_f32_16x16x32_bf16 v[168:171], a[176:179], v[240:243], v[168:171]
    v_exp_f32 v236, v236
    v_mfma_f32_16x16x32_bf16 v[168:171], a[180:183], v[244:247], v[168:171]
    s_cmp_lt_u32 s38, 5
    v_mfma_f32_16x16x32_bf16 v[172:175], a[184:187], v[240:243], v[172:175]
    v_exp_f32 v237, v237
    v_mfma_f32_16x16x32_bf16 v[172:175], a[188:191], v[244:247], v[172:175]
    v_cvt_pk_bf16_f32 v254, v236, v237
    s_cbranch_scc1 L_loop
    v_mfma_f32_16x16x32_bf16 v[224:227], a[96:99], a[0:3], 0
    v_exp_f32 v238, v238
    v_mfma_f32_16x16x32_bf16 v[224:227], a[100:103], a[4:7], v[224:227]
    buffer_load_dwordx4 v16, s[16:19], s26 offen offset:0 nt lds
    v_mfma_f32_16x16x32_bf16 v[224:227], a[104:107], a[8:11], v[224:227]
    v_exp_f32 v239, v239
    v_mfma_f32_16x16x32_bf16 v[224:227], a[108:111], a[12:15], v[224:227]
    v_cvt_pk_bf16_f32 v255, v238, v239
    v_mfma_f32_16x16x32_bf16 v[228:231], a[112:115], a[0:3], 0
    buffer_load_dwordx4 v17, s[16:19], s26 offen offset:1024 nt lds
    v_mfma_f32_16x16x32_bf16 v[228:231], a[116:119], a[4:7], v[228:231]
    v_mfma_f32_16x16x32_bf16 v[228:231], a[120:123], a[8:11], v[228:231]
    v_exp_f32 v224, v224
    v_mfma_f32_16x16x32_bf16 v[228:231], a[124:127], a[12:15], v[228:231]
    buffer_load_dwordx4 v16, s[16:19], s26 offen offset:2048 nt lds
    v_mfma_f32_16x16x32_bf16 v[232:235], a[128:131], a[0:3], 0
    v_exp_f32 v225, v225
    v_mfma_f32_16x16x32_bf16 v[232:235], a[132:135], a[4:7], v[232:235]
    v_cvt_pk_bf16_f32 v240, v224, v225
    v_mfma_f32_16x16x32_bf16 v[232:235], a[136:139], a[8:11], v[232:235]
    v_exp_f32 v226, v226
    v_mfma_f32_16x16x32_bf16 v[232:235], a[140:143], a[12:15], v[232:235]
    buffer_load_dwordx4 v17, s[16:19], s26 offen offset:3072 nt lds
    v_mfma_f32_16x16x32_bf16 v[236:239], a[144:147], a[0:3], 0
    v_exp_f32 v227, v227
    v_mfma_f32_16x16x32_bf16 v[236:239], a[148:151], a[4:7], v[236:239]
    v_cvt_pk_bf16_f32 v241, v226, v227
    s_mov_b32 m0, s31
    v_mfma_f32_16x16x32_bf16 v[236:239], a[152:155], a[8:11], v[236:239]
    v_exp_f32 v228, v228
    v_mfma_f32_16x16x32_bf16 v[236:239], a[156:159], a[12:15], v[236:239]
    buffer_load_dwordx4 v16, s[16:19], s27 offen offset:0 nt lds
    v_mfma_f32_16x16x32_bf16 a[244:247], a[248:251], v[248:251], a[244:247]
    v_exp_f32 v229, v229
    v_mfma_f32_16x16x32_bf16 a[244:247], a[248:251], v[252:255], a[244:247]
    v_cvt_pk_bf16_f32 v242, v228, v229
    v_mfma_f32_16x16x32_bf16 v[208:211], a[192:195], v[248:251], v[208:211]
    v_exp_f32 v230, v230
    v_mfma_f32_16x16x32_bf16 v[208:211], a[196:199], v[252:255], v[208:211]
    buffer_load_dwordx4 v17, s[16:19], s27 offen offset:1024 nt lds
    v_mfma_f32_16x16x32_bf16 v[212:215], a[200:203], v[248:251], v[212:215]
    v_exp_f32 v231, v231
    v_mfma_f32_16x16x32_bf16 v[212:215], a[204:207], v[252:255], v[212:215]
    buffer_load_dwordx4 v16, s[16:19], s27 offen offset:2048 nt lds
    v_cvt_pk_bf16_f32 v243, v230, v231
    v_mfma_f32_16x16x32_bf16 v[216:219], a[208:211], v[248:251], v[216:219]
    v_exp_f32 v232, v232
    v_mfma_f32_16x16x32_bf16 v[216:219], a[212:215], v[252:255], v[216:219]
    buffer_load_dwordx4 v17, s[16:19], s27 offen offset:3072 nt lds
    s_waitcnt vmcnt(9)
    s_barrier
    v_mfma_f32_16x16x32_bf16 v[220:223], a[216:219], v[248:251], v[220:223]
    v_exp_f32 v233, v233
    v_mfma_f32_16x16x32_bf16 v[220:223], a[220:223], v[252:255], v[220:223]
    ds_read_b64_tr_b16 a[192:193], v28 offset:0
    v_cvt_pk_bf16_f32 v244, v232, v233
    v_mfma_f32_16x16x32_bf16 v[192:195], a[160:163], v[248:251], v[192:195]
    v_exp_f32 v234, v234
    v_mfma_f32_16x16x32_bf16 v[192:195], a[164:167], v[252:255], v[192:195]
    ds_read_b64_tr_b16 a[194:195], v28 offset:4096
    ds_read_b64_tr_b16 a[196:197], v28 offset:8192
    v_mfma_f32_16x16x32_bf16 v[196:199], a[168:171], v[248:251], v[196:199]
    v_exp_f32 v235, v235
    v_mfma_f32_16x16x32_bf16 v[196:199], a[172:175], v[252:255], v[196:199]
    ds_read_b64_tr_b16 a[198:199], v28 offset:12288
    v_cvt_pk_bf16_f32 v245, v234, v235
    v_mfma_f32_16x16x32_bf16 v[200:203], a[176:179], v[248:251], v[200:203]
    v_exp_f32 v236, v236
    v_mfma_f32_16x16x32_bf16 v[200:203], a[180:183], v[252:255], v[200:203]
    ds_read_b64_tr_b16 a[200:201], v29 offset:0
    ds_read_b64_tr_b16 a[202:203], v29 offset:4096
    v_mfma_f32_16x16x32_bf16 v[204:207], a[184:187], v[248:251], v[204:207]
    v_exp_f32 v237, v237
    v_mfma_f32_16x16x32_bf16 v[204:207], a[188:191], v[252:255], v[204:207]
    ds_read_b64_tr_b16 a[204:205], v29 offset:8192
    v_cvt_pk_bf16_f32 v246, v236, v237
    v_mfma_f32_16x16x32_bf16 v[224:227], a[96:99], a[16:19], 0
    v_exp_f32 v238, v238
    v_mfma_f32_16x16x32_bf16 v[224:227], a[100:103], a[20:23], v[224:227]
    ds_read_b64_tr_b16 a[206:207], v29 offset:12288
    ds_read_b64_tr_b16 a[208:209], v30 offset:0
    v_mfma_f32_16x16x32_bf16 v[224:227], a[104:107], a[24:27], v[224:227]
    v_exp_f32 v239, v239
    v_mfma_f32_16x16x32_bf16 v[224:227], a[108:111], a[28:31], v[224:227]
    ds_read_b64_tr_b16 a[210:211], v30 offset:4096
    v_cvt_pk_bf16_f32 v247, v238, v239
    v_mfma_f32_16x16x32_bf16 v[228:231], a[112:115], a[16:19], 0
    ds_read_b64_tr_b16 a[212:213], v30 offset:8192
    ds_read_b64_tr_b16 a[214:215], v30 offset:12288
    v_mfma_f32_16x16x32_bf16 v[228:231], a[116:119], a[20:23], v[228:231]
    ds_read_b64_tr_b16 a[216:217], v31 offset:0
    ds_read_b64_tr_b16 a[218:219], v31 offset:4096
    v_mfma_f32_16x16x32_bf16 v[228:231], a[120:123], a[24:27], v[228:231]
    v_exp_f32 v224, v224
    v_mfma_f32_16x16x32_bf16 v[228:231], a[124:127], a[28:31], v[228:231]
    ds_read_b64_tr_b16 a[220:221], v31 offset:8192
    ds_read_b64_tr_b16 a[222:223], v31 offset:12288
    v_mfma_f32_16x16x32_bf16 v[232:235], a[128:131], a[16:19], 0
    v_exp_f32 v225, v225
    v_mfma_f32_16x16x32_bf16 v[232:235], a[132:135], a[20:23], v[232:235]
    ds_read_b64_tr_b16 a[160:161], v24 offset:0
    v_cvt_pk_bf16_f32 v248, v224, v225
    v_mfma_f32_16x16x32_bf16 v[232:235], a[136:139], a[24:27], v[232:235]
    v_exp_f32 v226, v226
    v_mfma_f32_16x16x32_bf16 v[232:235], a[140:143], a[28:31], v[232:235]
    ds_read_b64_tr_b16 a[162:163], v24 offset:4096
    ds_read_b64_tr_b16 a[164:165], v24 offset:8192
    v_mfma_f32_16x16x32_bf16 v[236:239], a[144:147], a[16:19], 0
    v_exp_f32 v227, v227
    v_mfma_f32_16x16x32_bf16 v[236:239], a[148:151], a[20:23], v[236:239]
    ds_read_b64_tr_b16 a[166:167], v24 offset:12288
    v_cvt_pk_bf16_f32 v249, v226, v227
    v_mfma_f32_16x16x32_bf16 v[236:239], a[152:155], a[24:27], v[236:239]
    v_exp_f32 v228, v228
    s_waitcnt lgkmcnt(8)
    v_mfma_f32_16x16x32_bf16 v[236:239], a[156:159], a[28:31], v[236:239]
    ds_read_b64_tr_b16 a[168:169], v25 offset:0
    ds_read_b64_tr_b16 a[170:171], v25 offset:4096
    v_mfma_f32_16x16x32_bf16 a[224:227], a[248:251], v[240:243], a[224:227]
    v_exp_f32 v229, v229
    v_mfma_f32_16x16x32_bf16 a[224:227], a[248:251], v[244:247], a[224:227]
    ds_read_b64_tr_b16 a[172:173], v25 offset:8192
    v_cvt_pk_bf16_f32 v250, v228, v229
    v_mfma_f32_16x16x32_bf16 v[48:51], a[192:195], v[240:243], v[48:51]
    v_exp_f32 v230, v230
    v_mfma_f32_16x16x32_bf16 v[48:51], a[196:199], v[244:247], v[48:51]
    ds_read_b64_tr_b16 a[174:175], v25 offset:12288
    ds_read_b64_tr_b16 a[176:177], v26 offset:0
    v_mfma_f32_16x16x32_bf16 v[52:55], a[200:203], v[240:243], v[52:55]
    v_exp_f32 v231, v231
    v_mfma_f32_16x16x32_bf16 v[52:55], a[204:207], v[244:247], v[52:55]
L_pg3:
    s_cbranch_execz L_back
    ds_read_b64_tr_b16 a[178:179], v26 offset:4096
    v_cvt_pk_bf16_f32 v251, v230, v231
    v_mfma_f32_16x16x32_bf16 v[56:59], a[208:211], v[240:243], v[56:59]
    v_exp_f32 v232, v232
    v_mfma_f32_16x16x32_bf16 v[56:59], a[212:215], v[244:247], v[56:59]
    ds_read_b64_tr_b16 a[180:181], v26 offset:8192
    ds_read_b64_tr_b16 a[182:183], v26 offset:12288
    ds_read_b64_tr_b16 a[184:185], v27 offset:0
    s_waitcnt lgkmcnt(5)
    v_mfma_f32_16x16x32_bf16 v[60:63], a[216:219], v[240:243], v[60:63]
    ds_read_b64_tr_b16 a[186:187], v27 offset:4096
    v_exp_f32 v233, v233
    v_mfma_f32_16x16x32_bf16 v[60:63], a[220:223], v[244:247], v[60:63]
    ds_read_b64_tr_b16 a[188:189], v27 offset:8192
    ds_read_b64_tr_b16 a[190:191], v27 offset:12288
    v_cvt_pk_bf16_f32 v252, v232, v233
    v_mfma_f32_16x16x32_bf16 v[32:35], a[160:163], v[240:243], v[32:35]
    v_exp_f32 v234, v234
    v_mfma_f32_16x16x32_bf16 v[32:35], a[164:167], v[244:247], v[32:35]
    v_xor_b32 v24, 0x8000, v24
    v_xor_b32 v25, 0x8000, v25
    v_mfma_f32_16x16x32_bf16 v[36:39], a[168:171], v[240:243], v[36:39]
    v_exp_f32 v235, v235
    v_mfma_f32_16x16x32_bf16 v[36:39], a[172:175], v[244:247], v[36:39]
    v_cvt_pk_bf16_f32 v253, v234, v235
    s_waitcnt lgkmcnt(0)
    v_mfma_f32_16x16x32_bf16 v[40:43], a[176:179], v[240:243], v[40:43]
    v_exp_f32 v236, v236
    v_mfma_f32_16x16x32_bf16 v[40:43], a[180:183], v[244:247], v[40:43]
    v_xor_b32 v26, 0x8000, v26
    v_xor_b32 v27, 0x8000, v27
    v_mfma_f32_16x16x32_bf16 v[44:47], a[184:187], v[240:243], v[44:47]
    v_exp_f32 v237, v237
    v_mfma_f32_16x16x32_bf16 v[44:47], a[188:191], v[244:247], v[44:47]
    v_cvt_pk_bf16_f32 v254, v236, v237
    v_xor_b32 v28, 0x8000, v28
    v_mfma_f32_16x16x32_bf16 v[224:227], a[96:99], a[32:35], 0
    ds_read_b128 a[96:99], v20 offset:0
    v_exp_f32 v238, v238
    v_mfma_f32_16x16x32_bf16 v[224:227], a[100:103], a[36:39], v[224:227]
    v_xor_b32 v29, 0x8000, v29
    v_xor_b32 v30, 0x8000, v30
    v_mfma_f32_16x16x32_bf16 v[224:227], a[104:107], a[40:43], v[224:227]
    v_exp_f32 v239, v239
    s_mov_b32 s52, 0x3f80
    s_mov_b32 s53, 0x3f800000
    v_mfma_f32_16x16x32_bf16 v[224:227], a[108:111], a[44:47], v[224:227]
    v_cvt_pk_bf16_f32 v255, v238, v239
    v_xor_b32 v31, 0x8000, v31
    v_mfma_f32_16x16x32_bf16 v[228:231], a[112:115], a[32:35], 0
    ds_read_b128 a[100:103], v21 offset:0
    ds_read_b128 a[104:107], v22 offset:0
    v_mfma_f32_16x16x32_bf16 v[228:231], a[116:119], a[36:39], v[228:231]
    ds_read_b128 a[108:111], v23 offset:0
    ds_read_b128 a[112:115], v20 offset:4096
    v_mfma_f32_16x16x32_bf16 v[228:231], a[120:123], a[40:43], v[228:231]
    v_exp_f32 v224, v224
    v_mfma_f32_16x16x32_bf16 v[228:231], a[124:127], a[44:47], v[228:231]
    ds_read_b128 a[116:119], v21 offset:4096
    ds_read_b128 a[120:123], v22 offset:4096
    v_mfma_f32_16x16x32_bf16 v[232:235], a[128:131], a[32:35], 0
    v_exp_f32 v225, v225
    v_mfma_f32_16x16x32_bf16 v[232:235], a[132:135], a[36:39], v[232:235]
    ds_read_b128 a[124:127], v23 offset:4096
    v_cvt_pk_bf16_f32 v240, v224, v225
    v_mfma_f32_16x16x32_bf16 v[232:235], a[136:139], a[40:43], v[232:235]
    v_exp_f32 v226, v226
    v_mfma_f32_16x16x32_bf16 v[232:235], a[140:143], a[44:47], v[232:235]
    ds_read_b128 a[128:131], v20 offset:8192
    ds_read_b128 a[132:135], v21 offset:8192
    v_mfma_f32_16x16x32_bf16 v[236:239], a[144:147], a[32:35], 0
    v_exp_f32 v227, v227
    v_mfma_f32_16x16x32_bf16 v[236:239], a[148:151], a[36:39], v[236:239]
    ds_read_b128 a[136:139], v22 offset:8192
    v_cvt_pk_bf16_f32 v241, v226, v227
    v_mfma_f32_16x16x32_bf16 v[236:239], a[152:155], a[40:43], v[236:239]
    v_exp_f32 v228, v228
    v_mfma_f32_16x16x32_bf16 v[236:239], a[156:159], a[44:47], v[236:239]
    ds_read_b128 a[140:143], v23 offset:8192
    ds_read_b128 a[144:147], v20 offset:12288
    v_mfma_f32_16x16x32_bf16 a[228:231], a[248:251], v[248:251], a[228:231]
    v_exp_f32 v229, v229
    v_mfma_f32_16x16x32_bf16 a[228:231], a[248:251], v[252:255], a[228:231]
    ds_read_b128 a[148:151], v21 offset:12288
    v_cvt_pk_bf16_f32 v242, v228, v229
    v_mfma_f32_16x16x32_bf16 v[80:83], a[192:195], v[248:251], v[80:83]
    v_exp_f32 v230, v230
    v_mfma_f32_16x16x32_bf16 v[80:83], a[196:199], v[252:255], v[80:83]
    ds_read_b128 a[152:155], v22 offset:12288
    ds_read_b128 a[156:159], v23 offset:12288
    v_mfma_f32_16x16x32_bf16 v[84:87], a[200:203], v[248:251], v[84:87]
    v_exp_f32 v231, v231
    v_mfma_f32_16x16x32_bf16 v[84:87], a[204:207], v[252:255], v[84:87]
    v_cvt_pk_bf16_f32 v243, v230, v231
    v_xor_b32 v20, 0x8000, v20
    v_mfma_f32_16x16x32_bf16 v[88:91], a[208:211], v[248:251], v[88:91]
    v_exp_f32 v232, v232
    v_mfma_f32_16x16x32_bf16 v[88:91], a[212:215], v[252:255], v[88:91]
    v_xor_b32 v21, 0x8000, v21
    v_xor_b32 v22, 0x8000, v22
    v_xor_b32 v23, 0x8000, v23
    v_mfma_f32_16x16x32_bf16 v[92:95], a[216:219], v[248:251], v[92:95]
    v_exp_f32 v233, v233
    v_mfma_f32_16x16x32_bf16 v[92:95], a[220:223], v[252:255], v[92:95]
    v_cvt_pk_bf16_f32 v244, v232, v233
    s_waitcnt lgkmcnt(0)
    v_mfma_f32_16x16x32_bf16 v[64:67], a[160:163], v[248:251], v[64:67]
    v_exp_f32 v234, v234
    v_mfma_f32_16x16x32_bf16 v[64:67], a[164:167], v[252:255], v[64:67]
    v_mfma_f32_16x16x32_bf16 v[68:71], a[168:171], v[248:251], v[68:71]
    v_exp_f32 v235, v235
    v_mfma_f32_16x16x32_bf16 v[68:71], a[172:175], v[252:255], v[68:71]
    v_cvt_pk_bf16_f32 v245, v234, v235
    v_mfma_f32_16x16x32_bf16 v[72:75], a[176:179], v[248:251], v[72:75]
    v_exp_f32 v236, v236
    v_mfma_f32_16x16x32_bf16 v[72:75], a[180:183], v[252:255], v[72:75]
    v_mfma_f32_16x16x32_bf16 v[76:79], a[184:187], v[248:251], v[76:79]
    v_exp_f32 v237, v237
    v_mfma_f32_16x16x32_bf16 v[76:79], a[188:191], v[252:255], v[76:79]
    v_cvt_pk_bf16_f32 v246, v236, v237
    v_mfma_f32_16x16x32_bf16 v[224:227], a[96:99], a[0:3], 0
    v_exp_f32 v238, v238
    v_mfma_f32_16x16x32_bf16 v[224:227], a[100:103], a[4:7], v[224:227]
    v_mfma_f32_16x16x32_bf16 v[224:227], a[104:107], a[8:11], v[224:227]
    v_exp_f32 v239, v239
    v_mfma_f32_16x16x32_bf16 v[224:227], a[108:111], a[12:15], v[224:227]
    v_cvt_pk_bf16_f32 v247, v238, v239
    v_mfma_f32_16x16x32_bf16 v[228:231], a[112:115], a[0:3], 0
    buffer_load_dword v10, off, s[44:47], s59 sc0 sc1
    v_mfma_f32_16x16x32_bf16 v[228:231], a[116:119], a[4:7], v[228:231]
    v_mfma_f32_16x16x32_bf16 v[228:231], a[120:123], a[8:11], v[228:231]
    v_exp_f32 v224, v224
    v_mfma_f32_16x16x32_bf16 v[228:231], a[124:127], a[12:15], v[228:231]
    v_mfma_f32_16x16x32_bf16 v[232:235], a[128:131], a[0:3], 0
    v_exp_f32 v225, v225
    v_mfma_f32_16x16x32_bf16 v[232:235], a[132:135], a[4:7], v[232:235]
    v_cvt_pk_bf16_f32 v248, v224, v225
    v_mfma_f32_16x16x32_bf16 v[232:235], a[136:139], a[8:11], v[232:235]
    v_exp_f32 v226, v226
    v_mfma_f32_16x16x32_bf16 v[232:235], a[140:143], a[12:15], v[232:235]
    v_mfma_f32_16x16x32_bf16 v[236:239], a[144:147], a[0:3], 0
    v_exp_f32 v227, v227
    v_mfma_f32_16x16x32_bf16 v[236:239], a[148:151], a[4:7], v[236:239]
    v_cvt_pk_bf16_f32 v249, v226, v227
    v_mfma_f32_16x16x32_bf16 v[236:239], a[152:155], a[8:11], v[236:239]
    v_exp_f32 v228, v228
    v_mfma_f32_16x16x32_bf16 v[236:239], a[156:159], a[12:15], v[236:239]
    v_mfma_f32_16x16x32_bf16 a[232:235], a[248:251], v[240:243], a[232:235]
    v_exp_f32 v229, v229
    v_mfma_f32_16x16x32_bf16 a[232:235], a[248:251], v[244:247], a[232:235]
    v_cvt_pk_bf16_f32 v250, v228, v229
    v_mfma_f32_16x16x32_bf16 v[112:115], a[192:195], v[240:243], v[112:115]
    v_exp_f32 v230, v230
    v_mfma_f32_16x16x32_bf16 v[112:115], a[196:199], v[244:247], v[112:115]
    v_mfma_f32_16x16x32_bf16 v[116:119], a[200:203], v[240:243], v[116:119]
    v_exp_f32 v231, v231
    v_mfma_f32_16x16x32_bf16 v[116:119], a[204:207], v[244:247], v[116:119]
    v_cvt_pk_bf16_f32 v251, v230, v231
    v_mfma_f32_16x16x32_bf16 v[120:123], a[208:211], v[240:243], v[120:123]
    v_exp_f32 v232, v232
    v_mfma_f32_16x16x32_bf16 v[120:123], a[212:215], v[244:247], v[120:123]
    s_waitcnt vmcnt(1)
    s_barrier
    v_mfma_f32_16x16x32_bf16 v[124:127], a[216:219], v[240:243], v[124:127]
    v_exp_f32 v233, v233
    v_mfma_f32_16x16x32_bf16 v[124:127], a[220:223], v[244:247], v[124:127]
    ds_read_b64_tr_b16 a[192:193], v28 offset:0
    v_cvt_pk_bf16_f32 v252, v232, v233
    v_mfma_f32_16x16x32_bf16 v[96:99], a[160:163], v[240:243], v[96:99]
    v_exp_f32 v234, v234
    v_mfma_f32_16x16x32_bf16 v[96:99], a[164:167], v[244:247], v[96:99]
    ds_read_b64_tr_b16 a[194:195], v28 offset:4096
    ds_read_b64_tr_b16 a[196:197], v28 offset:8192
    v_mfma_f32_16x16x32_bf16 v[100:103], a[168:171], v[240:243], v[100:103]
    v_exp_f32 v235, v235
    v_mfma_f32_16x16x32_bf16 v[100:103], a[172:175], v[244:247], v[100:103]
    ds_read_b64_tr_b16 a[198:199], v28 offset:12288
    v_cvt_pk_bf16_f32 v253, v234, v235
    v_mfma_f32_16x16x32_bf16 v[104:107], a[176:179], v[240:243], v[104:107]
    v_exp_f32 v236, v236
    v_mfma_f32_16x16x32_bf16 v[104:107], a[180:183], v[244:247], v[104:107]
    ds_read_b64_tr_b16 a[200:201], v29 offset:0
    ds_read_b64_tr_b16 a[202:203], v29 offset:4096
    v_mfma_f32_16x16x32_bf16 v[108:111], a[184:187], v[240:243], v[108:111]
    v_exp_f32 v237, v237
    v_mfma_f32_16x16x32_bf16 v[108:111], a[188:191], v[244:247], v[108:111]
    ds_read_b64_tr_b16 a[204:205], v29 offset:8192
    v_cvt_pk_bf16_f32 v254, v236, v237
    v_mfma_f32_16x16x32_bf16 v[224:227], a[96:99], a[16:19], 0
    v_exp_f32 v238, v238
    v_mfma_f32_16x16x32_bf16 v[224:227], a[100:103], a[20:23], v[224:227]
    ds_read_b64_tr_b16 a[206:207], v29 offset:12288
    ds_read_b64_tr_b16 a[208:209], v30 offset:0
    v_mfma_f32_16x16x32_bf16 v[224:227], a[104:107], a[24:27], v[224:227]
    v_exp_f32 v239, v239
    v_mfma_f32_16x16x32_bf16 v[224:227], a[108:111], a[28:31], v[224:227]
    ds_read_b64_tr_b16 a[210:211], v30 offset:4096
    v_cvt_pk_bf16_f32 v255, v238, v239
    v_mfma_f32_16x16x32_bf16 v[228:231], a[112:115], a[16:19], 0
    ds_read_b64_tr_b16 a[212:213], v30 offset:8192
    ds_read_b64_tr_b16 a[214:215], v30 offset:12288
    v_mfma_f32_16x16x32_bf16 v[228:231], a[116:119], a[20:23], v[228:231]
    ds_read_b64_tr_b16 a[216:217], v31 offset:0
    ds_read_b64_tr_b16 a[218:219], v31 offset:4096
    v_mfma_f32_16x16x32_bf16 v[228:231], a[120:123], a[24:27], v[228:231]
    v_exp_f32 v224, v224
    v_mfma_f32_16x16x32_bf16 v[228:231], a[124:127], a[28:31], v[228:231]
    ds_read_b64_tr_b16 a[220:221], v31 offset:8192
    ds_read_b64_tr_b16 a[222:223], v31 offset:12288
    v_mfma_f32_16x16x32_bf16 v[232:235], a[128:131], a[16:19], 0
    v_exp_f32 v225, v225
    v_mfma_f32_16x16x32_bf16 v[232:235], a[132:135], a[20:23], v[232:235]
    ds_read_b64_tr_b16 a[160:161], v24 offset:0
    v_cvt_pk_bf16_f32 v240, v224, v225
    v_mfma_f32_16x16x32_bf16 v[232:235], a[136:139], a[24:27], v[232:235]
    v_exp_f32 v226, v226
    v_mfma_f32_16x16x32_bf16 v[232:235], a[140:143], a[28:31], v[232:235]
    ds_read_b64_tr_b16 a[162:163], v24 offset:4096
    ds_read_b64_tr_b16 a[164:165], v24 offset:8192
    v_mfma_f32_16x16x32_bf16 v[236:239], a[144:147], a[16:19], 0
    v_exp_f32 v227, v227
    v_mfma_f32_16x16x32_bf16 v[236:239], a[148:151], a[20:23], v[236:239]
    ds_read_b64_tr_b16 a[166:167], v24 offset:12288
    v_cvt_pk_bf16_f32 v241, v226, v227
    v_mfma_f32_16x16x32_bf16 v[236:239], a[152:155], a[24:27], v[236:239]
    v_exp_f32 v228, v228
    s_waitcnt lgkmcnt(8)
    v_mfma_f32_16x16x32_bf16 v[236:239], a[156:159], a[28:31], v[236:239]
    ds_read_b64_tr_b16 a[168:169], v25 offset:0
    ds_read_b64_tr_b16 a[170:171], v25 offset:4096
    v_mfma_f32_16x16x32_bf16 a[224:227], a[248:251], v[248:251], a[224:227]
    v_exp_f32 v229, v229
    v_mfma_f32_16x16x32_bf16 a[224:227], a[248:251], v[252:255], a[224:227]
    ds_read_b64_tr_b16 a[172:173], v25 offset:8192
    v_cvt_pk_bf16_f32 v242, v228, v229
    v_mfma_f32_16x16x32_bf16 v[48:51], a[192:195], v[248:251], v[48:51]
    v_exp_f32 v230, v230
    v_mfma_f32_16x16x32_bf16 v[48:51], a[196:199], v[252:255], v[48:51]
    ds_read_b64_tr_b16 a[174:175], v25 offset:12288
    ds_read_b64_tr_b16 a[176:177], v26 offset:0
    v_mfma_f32_16x16x32_bf16 v[52:55], a[200:203], v[248:251], v[52:55]
    ds_write_b32 v6, a224 offset:0
    v_exp_f32 v231, v231
    v_mfma_f32_16x16x32_bf16 v[52:55], a[204:207], v[252:255], v[52:55]
    ds_read_b64_tr_b16 a[178:179], v26 offset:4096
    v_cvt_pk_bf16_f32 v243, v230, v231
    v_mfma_f32_16x16x32_bf16 v[56:59], a[208:211], v[248:251], v[56:59]
    ds_write_b128 v2, v[48:51] offset:0
    v_exp_f32 v232, v232
    v_mfma_f32_16x16x32_bf16 v[56:59], a[212:215], v[252:255], v[56:59]
    ds_read_b64_tr_b16 a[180:181], v26 offset:8192
    ds_read_b64_tr_b16 a[182:183], v26 offset:12288
    ds_read_b64_tr_b16 a[184:185], v27 offset:0
    s_waitcnt lgkmcnt(7)
    v_mfma_f32_16x16x32_bf16 v[60:63], a[216:219], v[248:251], v[60:63]
    ds_read_b64_tr_b16 a[186:187], v27 offset:4096
    v_exp_f32 v233, v233
    v_mfma_f32_16x16x32_bf16 v[60:63], a[220:223], v[252:255], v[60:63]
    ds_read_b64_tr_b16 a[188:189], v27 offset:8192
    ds_read_b64_tr_b16 a[190:191], v27 offset:12288
    v_cvt_pk_bf16_f32 v244, v232, v233
    v_mfma_f32_16x16x32_bf16 v[32:35], a[160:163], v[248:251], v[32:35]
    ds_write_b128 v2, v[52:55] offset:1024
    v_exp_f32 v234, v234
    v_mfma_f32_16x16x32_bf16 v[32:35], a[164:167], v[252:255], v[32:35]
    v_xor_b32 v24, 0x8000, v24
    v_xor_b32 v25, 0x8000, v25
    v_mfma_f32_16x16x32_bf16 v[36:39], a[168:171], v[248:251], v[36:39]
    ds_write_b128 v2, v[56:59] offset:2048
    v_exp_f32 v235, v235
    v_mfma_f32_16x16x32_bf16 v[36:39], a[172:175], v[252:255], v[36:39]
    v_cvt_pk_bf16_f32 v245, v234, v235
    s_waitcnt lgkmcnt(2)
    s_waitcnt vmcnt(0)
    v_mfma_f32_16x16x32_bf16 v[40:43], a[176:179], v[248:251], v[40:43]
    v_exp_f32 v236, v236
    v_and_b32 v10, s73, v10
    v_mfma_f32_16x16x32_bf16 v[40:43], a[180:183], v[252:255], v[40:43]
    ds_write_b128 v2, v[60:63] offset:3072
    v_xor_b32 v26, 0x8000, v26
    v_xor_b32 v27, 0x8000, v27
    v_mfma_f32_16x16x32_bf16 v[44:47], a[184:187], v[248:251], v[44:47]
    v_exp_f32 v237, v237
    v_cmp_eq_u32 vcc, 0, v10
    v_mfma_f32_16x16x32_bf16 v[44:47], a[188:191], v[252:255], v[44:47]
    v_cvt_pk_bf16_f32 v246, v236, v237
    v_xor_b32 v28, 0x8000, v28
    v_mfma_f32_16x16x32_bf16 v[224:227], a[96:99], a[32:35], 0
    v_exp_f32 v238, v238
    v_mfma_f32_16x16x32_bf16 v[224:227], a[100:103], a[36:39], v[224:227]
    v_xor_b32 v29, 0x8000, v29
    v_xor_b32 v30, 0x8000, v30
    s_waitcnt lgkmcnt(0)
    s_barrier
    v_mfma_f32_16x16x32_bf16 v[224:227], a[104:107], a[40:43], v[224:227]
    ds_read_b64 v[12:13], v7 offset:0
    v_exp_f32 v239, v239
    v_mfma_f32_16x16x32_bf16 v[224:227], a[108:111], a[44:47], v[224:227]
    ds_read_b128 v[48:51], v3 offset:0
    v_cvt_pk_bf16_f32 v247, v238, v239
    v_xor_b32 v31, 0x8000, v31
    v_mfma_f32_16x16x32_bf16 v[228:231], a[112:115], a[32:35], 0
    ds_read_b128 v[52:55], v3 offset:1024
    s_cbranch_vccnz L_spinf
L_spinf_ret:
    v_mfma_f32_16x16x32_bf16 v[228:231], a[116:119], a[36:39], v[228:231]
    ds_read_b128 v[56:59], v3 offset:2048
    v_mfma_f32_16x16x32_bf16 v[228:231], a[120:123], a[40:43], v[228:231]
    ds_read_b128 v[60:63], v3 offset:3072
    v_exp_f32 v224, v224
    v_mfma_f32_16x16x32_bf16 v[228:231], a[124:127], a[44:47], v[228:231]
    v_mfma_f32_16x16x32_bf16 v[232:235], a[128:131], a[32:35], 0
    v_exp_f32 v225, v225
    v_mfma_f32_16x16x32_bf16 v[232:235], a[132:135], a[36:39], v[232:235]
    v_cvt_pk_bf16_f32 v248, v224, v225
    v_mfma_f32_16x16x32_bf16 v[232:235], a[136:139], a[40:43], v[232:235]
    v_exp_f32 v226, v226
    s_waitcnt lgkmcnt(4)
    v_mfma_f32_16x16x32_bf16 v[232:235], a[140:143], a[44:47], v[232:235]
    v_add_f32 v12, v12, v13
    s_waitcnt lgkmcnt(2)
    v_mfma_f32_16x16x32_bf16 v[236:239], a[144:147], a[32:35], 0
    v_exp_f32 v227, v227
    v_add_f32 v32, v32, v48
    v_mfma_f32_16x16x32_bf16 v[236:239], a[148:151], a[36:39], v[236:239]
    buffer_store_dword v12, v5, s[8:11], s57 offen sc0 sc1
    v_cvt_pk_bf16_f32 v249, v226, v227
    v_mfma_f32_16x16x32_bf16 v[236:239], a[152:155], a[40:43], v[236:239]
    v_exp_f32 v228, v228
    v_add_f32 v33, v33, v49
    v_mfma_f32_16x16x32_bf16 v[236:239], a[156:159], a[44:47], v[236:239]
    v_add_f32 v34, v34, v50
    v_add_f32 v35, v35, v51
    v_add_f32 v36, v36, v52
    v_mfma_f32_16x16x32_bf16 a[228:231], a[248:251], v[240:243], a[228:231]
    v_exp_f32 v229, v229
    v_add_f32 v37, v37, v53
    v_mfma_f32_16x16x32_bf16 a[228:231], a[248:251], v[244:247], a[228:231]
    v_cvt_pk_bf16_f32 v250, v228, v229
    v_add_f32 v38, v38, v54
    v_add_f32 v39, v39, v55
    v_mfma_f32_16x16x32_bf16 v[80:83], a[192:195], v[240:243], v[80:83]
    v_exp_f32 v230, v230
    v_cvt_pk_bf16_f32 v32, v32, v33
    v_mfma_f32_16x16x32_bf16 v[80:83], a[196:199], v[244:247], v[80:83]
    v_cvt_pk_bf16_f32 v33, v34, v35
    v_cvt_pk_bf16_f32 v34, v36, v37
    v_cvt_pk_bf16_f32 v35, v38, v39
    v_mfma_f32_16x16x32_bf16 v[84:87], a[200:203], v[240:243], v[84:87]
    ds_write_b32 v6, a228 offset:256
    v_exp_f32 v231, v231
    v_mfma_f32_16x16x32_bf16 v[84:87], a[204:207], v[244:247], v[84:87]
    buffer_store_dwordx4 v[32:35], v4, s[8:11], 0 offen sc0 sc1
    v_cvt_pk_bf16_f32 v251, v230, v231
    v_mfma_f32_16x16x32_bf16 v[88:91], a[208:211], v[240:243], v[88:91]
    ds_write_b128 v2, v[80:83] offset:4096
    v_exp_f32 v232, v232
    v_mfma_f32_16x16x32_bf16 v[88:91], a[212:215], v[244:247], v[88:91]
    s_waitcnt lgkmcnt(2)
    v_mfma_f32_16x16x32_bf16 v[92:95], a[216:219], v[240:243], v[92:95]
    v_exp_f32 v233, v233
    v_add_f32 v40, v40, v56
    v_mfma_f32_16x16x32_bf16 v[92:95], a[220:223], v[244:247], v[92:95]
    ds_write_b128 v2, v[84:87] offset:5120
    v_cvt_pk_bf16_f32 v252, v232, v233
    v_add_f32 v41, v41, v57
    v_mfma_f32_16x16x32_bf16 v[64:67], a[160:163], v[240:243], v[64:67]
    v_exp_f32 v234, v234
    v_add_f32 v42, v42, v58
    v_mfma_f32_16x16x32_bf16 v[64:67], a[164:167], v[244:247], v[64:67]
    v_add_f32 v43, v43, v59
    v_add_f32 v44, v44, v60
    v_add_f32 v45, v45, v61
    v_mfma_f32_16x16x32_bf16 v[68:71], a[168:171], v[240:243], v[68:71]
    ds_write_b128 v2, v[88:91] offset:6144
    v_exp_f32 v235, v235
    v_mfma_f32_16x16x32_bf16 v[68:71], a[172:175], v[244:247], v[68:71]
    v_cvt_pk_bf16_f32 v253, v234, v235
    v_add_f32 v46, v46, v62
    v_add_f32 v47, v47, v63
    v_mfma_f32_16x16x32_bf16 v[72:75], a[176:179], v[240:243], v[72:75]
    v_exp_f32 v236, v236
    v_cvt_pk_bf16_f32 v40, v40, v41
    v_mfma_f32_16x16x32_bf16 v[72:75], a[180:183], v[244:247], v[72:75]
    ds_write_b128 v2, v[92:95] offset:7168
    v_cvt_pk_bf16_f32 v41, v42, v43
    v_cvt_pk_bf16_f32 v42, v44, v45
    v_mfma_f32_16x16x32_bf16 v[76:79], a[184:187], v[240:243], v[76:79]
    v_exp_f32 v237, v237
    v_cvt_pk_bf16_f32 v43, v46, v47
    v_mfma_f32_16x16x32_bf16 v[76:79], a[188:191], v[244:247], v[76:79]
    buffer_store_dwordx4 v[40:43], v4, s[8:11], s56 offen sc0 sc1
    v_cvt_pk_bf16_f32 v254, v236, v237
    v_mfma_f32_16x16x32_bf16 v[224:227], a[96:99], a[48:51], 0
    v_exp_f32 v238, v238
    v_mfma_f32_16x16x32_bf16 v[224:227], a[100:103], a[52:55], v[224:227]
    s_waitcnt lgkmcnt(0)
    s_barrier
    v_mfma_f32_16x16x32_bf16 v[224:227], a[104:107], a[56:59], v[224:227]
    ds_read_b64 v[14:15], v7 offset:256
    v_exp_f32 v239, v239
    v_mfma_f32_16x16x32_bf16 v[224:227], a[108:111], a[60:63], v[224:227]
    ds_read_b128 v[80:83], v3 offset:4096
    v_cvt_pk_bf16_f32 v255, v238, v239
    v_mfma_f32_16x16x32_bf16 v[228:231], a[112:115], a[48:51], 0
    ds_read_b128 v[84:87], v3 offset:5120
    v_mfma_f32_16x16x32_bf16 v[228:231], a[116:119], a[52:55], v[228:231]
    ds_read_b128 v[88:91], v3 offset:6144
    v_mfma_f32_16x16x32_bf16 v[228:231], a[120:123], a[56:59], v[228:231]
    ds_read_b128 v[92:95], v3 offset:7168
    v_exp_f32 v224, v224
    v_mfma_f32_16x16x32_bf16 v[228:231], a[124:127], a[60:63], v[228:231]
    v_mfma_f32_16x16x32_bf16 v[232:235], a[128:131], a[48:51], 0
    v_exp_f32 v225, v225
    v_mfma_f32_16x16x32_bf16 v[232:235], a[132:135], a[52:55], v[232:235]
    v_cvt_pk_bf16_f32 v240, v224, v225
    v_mfma_f32_16x16x32_bf16 v[232:235], a[136:139], a[56:59], v[232:235]
    v_exp_f32 v226, v226
    s_waitcnt lgkmcnt(4)
    v_mfma_f32_16x16x32_bf16 v[232:235], a[140:143], a[60:63], v[232:235]
    v_add_f32 v14, v14, v15
    s_waitcnt lgkmcnt(2)
    v_mfma_f32_16x16x32_bf16 v[236:239], a[144:147], a[48:51], 0
    v_exp_f32 v227, v227
    v_add_f32 v64, v64, v80
    v_mfma_f32_16x16x32_bf16 v[236:239], a[148:151], a[52:55], v[236:239]
    buffer_store_dword v14, v5, s[8:11], s65 offen sc0 sc1
    v_cvt_pk_bf16_f32 v241, v226, v227
    v_mfma_f32_16x16x32_bf16 v[236:239], a[152:155], a[56:59], v[236:239]
    v_exp_f32 v228, v228
    v_add_f32 v65, v65, v81
    v_mfma_f32_16x16x32_bf16 v[236:239], a[156:159], a[60:63], v[236:239]
    v_add_f32 v66, v66, v82
    v_add_f32 v67, v67, v83
    v_add_f32 v68, v68, v84
    v_mfma_f32_16x16x32_bf16 a[232:235], a[248:251], v[248:251], a[232:235]
    v_exp_f32 v229, v229
    v_add_f32 v69, v69, v85
    v_mfma_f32_16x16x32_bf16 a[232:235], a[248:251], v[252:255], a[232:235]
    v_cvt_pk_bf16_f32 v242, v228, v229
    v_add_f32 v70, v70, v86
    v_add_f32 v71, v71, v87
    v_mfma_f32_16x16x32_bf16 v[112:115], a[192:195], v[248:251], v[112:115]
    v_exp_f32 v230, v230
    v_cvt_pk_bf16_f32 v64, v64, v65
    v_mfma_f32_16x16x32_bf16 v[112:115], a[196:199], v[252:255], v[112:115]
    v_cvt_pk_bf16_f32 v65, v66, v67
    v_cvt_pk_bf16_f32 v66, v68, v69
    v_cvt_pk_bf16_f32 v67, v70, v71
    v_mfma_f32_16x16x32_bf16 v[116:119], a[200:203], v[248:251], v[116:119]
    ds_write_b32 v6, a232 offset:512
    v_exp_f32 v231, v231
    v_mfma_f32_16x16x32_bf16 v[116:119], a[204:207], v[252:255], v[116:119]
    buffer_store_dwordx4 v[64:67], v4, s[8:11], s58 offen sc0 sc1
    v_cvt_pk_bf16_f32 v243, v230, v231
    v_mfma_f32_16x16x32_bf16 v[120:123], a[208:211], v[248:251], v[120:123]
    ds_write_b128 v2, v[112:115] offset:0
    v_exp_f32 v232, v232
    v_mfma_f32_16x16x32_bf16 v[120:123], a[212:215], v[252:255], v[120:123]
    s_waitcnt lgkmcnt(2)
    v_mfma_f32_16x16x32_bf16 v[124:127], a[216:219], v[248:251], v[124:127]
    v_exp_f32 v233, v233
    v_add_f32 v72, v72, v88
    v_mfma_f32_16x16x32_bf16 v[124:127], a[220:223], v[252:255], v[124:127]
    ds_write_b128 v2, v[116:119] offset:1024
    v_cvt_pk_bf16_f32 v244, v232, v233
    v_add_f32 v73, v73, v89
    v_mfma_f32_16x16x32_bf16 v[96:99], a[160:163], v[248:251], v[96:99]
    v_exp_f32 v234, v234
    v_add_f32 v74, v74, v90
    v_mfma_f32_16x16x32_bf16 v[96:99], a[164:167], v[252:255], v[96:99]
    v_add_f32 v75, v75, v91
    v_add_f32 v76, v76, v92
    v_add_f32 v77, v77, v93
    v_mfma_f32_16x16x32_bf16 v[100:103], a[168:171], v[248:251], v[100:103]
    ds_write_b128 v2, v[120:123] offset:2048
    v_exp_f32 v235, v235
    v_mfma_f32_16x16x32_bf16 v[100:103], a[172:175], v[252:255], v[100:103]
    v_cvt_pk_bf16_f32 v245, v234, v235
    v_add_f32 v78, v78, v94
    v_add_f32 v79, v79, v95
    v_mfma_f32_16x16x32_bf16 v[104:107], a[176:179], v[248:251], v[104:107]
    v_exp_f32 v236, v236
    v_cvt_pk_bf16_f32 v72, v72, v73
    v_mfma_f32_16x16x32_bf16 v[104:107], a[180:183], v[252:255], v[104:107]
    ds_write_b128 v2, v[124:127] offset:3072
    v_cvt_pk_bf16_f32 v73, v74, v75
    v_cvt_pk_bf16_f32 v74, v76, v77
    v_mfma_f32_16x16x32_bf16 v[108:111], a[184:187], v[248:251], v[108:111]
    v_exp_f32 v237, v237
    v_cvt_pk_bf16_f32 v75, v78, v79
    v_mfma_f32_16x16x32_bf16 v[108:111], a[188:191], v[252:255], v[108:111]
    buffer_store_dwordx4 v[72:75], v4, s[8:11], s64 offen sc0 sc1
    v_cvt_pk_bf16_f32 v246, v236, v237
    v_mfma_f32_16x16x32_bf16 v[224:227], a[96:99], a[64:67], 0
    v_exp_f32 v238, v238
    v_mfma_f32_16x16x32_bf16 v[224:227], a[100:103], a[68:71], v[224:227]
    s_waitcnt lgkmcnt(0)
    s_barrier
    v_mfma_f32_16x16x32_bf16 v[224:227], a[104:107], a[72:75], v[224:227]
    ds_read_b64 v[16:17], v7 offset:512
    v_exp_f32 v239, v239
    v_mfma_f32_16x16x32_bf16 v[224:227], a[108:111], a[76:79], v[224:227]
    ds_read_b128 v[112:115], v3 offset:0
    v_cvt_pk_bf16_f32 v247, v238, v239
    v_mfma_f32_16x16x32_bf16 v[228:231], a[112:115], a[64:67], 0
    ds_read_b128 v[116:119], v3 offset:1024
    v_mfma_f32_16x16x32_bf16 v[228:231], a[116:119], a[68:71], v[228:231]
    ds_read_b128 v[120:123], v3 offset:2048
    v_mfma_f32_16x16x32_bf16 v[228:231], a[120:123], a[72:75], v[228:231]
    ds_read_b128 v[124:127], v3 offset:3072
    v_exp_f32 v224, v224
    v_mfma_f32_16x16x32_bf16 v[228:231], a[124:127], a[76:79], v[228:231]
    v_mfma_f32_16x16x32_bf16 v[232:235], a[128:131], a[64:67], 0
    v_exp_f32 v225, v225
    v_mfma_f32_16x16x32_bf16 v[232:235], a[132:135], a[68:71], v[232:235]
    v_cvt_pk_bf16_f32 v248, v224, v225
    v_mfma_f32_16x16x32_bf16 v[232:235], a[136:139], a[72:75], v[232:235]
    v_exp_f32 v226, v226
    s_waitcnt lgkmcnt(4)
    v_mfma_f32_16x16x32_bf16 v[232:235], a[140:143], a[76:79], v[232:235]
    v_add_f32 v16, v16, v17
    s_waitcnt lgkmcnt(2)
    v_mfma_f32_16x16x32_bf16 v[236:239], a[144:147], a[64:67], 0
    v_exp_f32 v227, v227
    v_add_f32 v96, v96, v112
    v_mfma_f32_16x16x32_bf16 v[236:239], a[148:151], a[68:71], v[236:239]
    buffer_store_dword v16, v5, s[8:11], s62 offen sc0 sc1
    v_cvt_pk_bf16_f32 v249, v226, v227
    v_mfma_f32_16x16x32_bf16 v[236:239], a[152:155], a[72:75], v[236:239]
    v_exp_f32 v228, v228
    v_add_f32 v97, v97, v113
    v_mfma_f32_16x16x32_bf16 v[236:239], a[156:159], a[76:79], v[236:239]
    v_add_f32 v98, v98, v114
    v_add_f32 v99, v99, v115
    v_add_f32 v100, v100, v116
    v_mfma_f32_16x16x32_bf16 a[236:239], a[248:251], v[240:243], a[236:239]
    v_exp_f32 v229, v229
    v_add_f32 v101, v101, v117
    v_mfma_f32_16x16x32_bf16 a[236:239], a[248:251], v[244:247], a[236:239]
    v_cvt_pk_bf16_f32 v250, v228, v229
    v_add_f32 v102, v102, v118
    v_add_f32 v103, v103, v119
    v_mfma_f32_16x16x32_bf16 v[144:147], a[192:195], v[240:243], v[144:147]
    v_exp_f32 v230, v230
    v_cvt_pk_bf16_f32 v96, v96, v97
    v_mfma_f32_16x16x32_bf16 v[144:147], a[196:199], v[244:247], v[144:147]
    v_cvt_pk_bf16_f32 v97, v98, v99
    v_cvt_pk_bf16_f32 v98, v100, v101
    v_cvt_pk_bf16_f32 v99, v102, v103
    v_mfma_f32_16x16x32_bf16 v[148:151], a[200:203], v[240:243], v[148:151]
    v_exp_f32 v231, v231
    s_waitcnt lgkmcnt(0)
    v_mfma_f32_16x16x32_bf16 v[148:151], a[204:207], v[244:247], v[148:151]
    buffer_store_dwordx4 v[96:99], v4, s[8:11], s66 offen sc0 sc1
    v_cvt_pk_bf16_f32 v251, v230, v231
    v_mfma_f32_16x16x32_bf16 v[152:155], a[208:211], v[240:243], v[152:155]
    v_exp_f32 v232, v232
    v_add_f32 v104, v104, v120
    v_mfma_f32_16x16x32_bf16 v[152:155], a[212:215], v[244:247], v[152:155]
    v_add_f32 v105, v105, v121
    v_add_f32 v106, v106, v122
    v_add_f32 v107, v107, v123
    v_mfma_f32_16x16x32_bf16 v[156:159], a[216:219], v[240:243], v[156:159]
    v_exp_f32 v233, v233
    v_add_f32 v108, v108, v124
    v_mfma_f32_16x16x32_bf16 v[156:159], a[220:223], v[244:247], v[156:159]
    v_cvt_pk_bf16_f32 v252, v232, v233
    v_add_f32 v109, v109, v125
    v_add_f32 v110, v110, v126
    v_mfma_f32_16x16x32_bf16 v[128:131], a[160:163], v[240:243], v[128:131]
    v_exp_f32 v234, v234
    v_add_f32 v111, v111, v127
    v_mfma_f32_16x16x32_bf16 v[128:131], a[164:167], v[244:247], v[128:131]
    v_cvt_pk_bf16_f32 v104, v104, v105
    v_cvt_pk_bf16_f32 v105, v106, v107
    v_cvt_pk_bf16_f32 v106, v108, v109
    v_mfma_f32_16x16x32_bf16 v[132:135], a[168:171], v[240:243], v[132:135]
    v_exp_f32 v235, v235
    v_cvt_pk_bf16_f32 v107, v110, v111
    v_mfma_f32_16x16x32_bf16 v[132:135], a[172:175], v[244:247], v[132:135]
    buffer_store_dwordx4 v[104:107], v4, s[8:11], s61 offen sc0 sc1
    v_cvt_pk_bf16_f32 v253, v234, v235
    v_mfma_f32_16x16x32_bf16 v[136:139], a[176:179], v[240:243], v[136:139]
    v_exp_f32 v236, v236
    v_mfma_f32_16x16x32_bf16 v[136:139], a[180:183], v[244:247], v[136:139]
    v_mfma_f32_16x16x32_bf16 v[140:143], a[184:187], v[240:243], v[140:143]
    v_exp_f32 v237, v237
    v_mfma_f32_16x16x32_bf16 v[140:143], a[188:191], v[244:247], v[140:143]
    v_cvt_pk_bf16_f32 v254, v236, v237
    v_mfma_f32_16x16x32_bf16 v[224:227], a[96:99], a[80:83], 0
    v_exp_f32 v238, v238
    v_mfma_f32_16x16x32_bf16 v[224:227], a[100:103], a[84:87], v[224:227]
    ds_read_b128 a[96:99], v20 offset:0
    ds_read_b128 a[100:103], v21 offset:0
    v_mfma_f32_16x16x32_bf16 v[224:227], a[104:107], a[88:91], v[224:227]
    v_exp_f32 v239, v239
    v_mfma_f32_16x16x32_bf16 v[224:227], a[108:111], a[92:95], v[224:227]
    ds_read_b128 a[104:107], v22 offset:0
    v_cvt_pk_bf16_f32 v255, v238, v239
    v_mfma_f32_16x16x32_bf16 v[228:231], a[112:115], a[80:83], 0
    ds_read_b128 a[108:111], v23 offset:0
    ds_read_b128 a[112:115], v20 offset:4096
    v_mfma_f32_16x16x32_bf16 v[228:231], a[116:119], a[84:87], v[228:231]
L_pg4:
    s_cbranch_execz L_back
    ds_read_b128 a[116:119], v21 offset:4096
    v_mfma_f32_16x16x32_bf16 v[228:231], a[120:123], a[88:91], v[228:231]
    v_exp_f32 v224, v224
    v_mfma_f32_16x16x32_bf16 v[228:231], a[124:127], a[92:95], v[228:231]
    ds_read_b128 a[120:123], v22 offset:4096
    ds_read_b128 a[124:127], v23 offset:4096
    v_mfma_f32_16x16x32_bf16 v[232:235], a[128:131], a[80:83], 0
    v_exp_f32 v225, v225
    v_mfma_f32_16x16x32_bf16 v[232:235], a[132:135], a[84:87], v[232:235]
    ds_read_b128 a[128:131], v20 offset:8192
    v_cvt_pk_bf16_f32 v240, v224, v225
    v_mfma_f32_16x16x32_bf16 v[232:235], a[136:139], a[88:91], v[232:235]
    v_exp_f32 v226, v226
    v_mfma_f32_16x16x32_bf16 v[232:235], a[140:143], a[92:95], v[232:235]
    ds_read_b128 a[132:135], v21 offset:8192
    ds_read_b128 a[136:139], v22 offset:8192
    v_mfma_f32_16x16x32_bf16 v[236:239], a[144:147], a[80:83], 0
    v_exp_f32 v227, v227
    v_mfma_f32_16x16x32_bf16 v[236:239], a[148:151], a[84:87], v[236:239]
    ds_read_b128 a[140:143], v23 offset:8192
    v_cvt_pk_bf16_f32 v241, v226, v227
    v_mfma_f32_16x16x32_bf16 v[236:239], a[152:155], a[88:91], v[236:239]
    v_exp_f32 v228, v228
    v_mfma_f32_16x16x32_bf16 v[236:239], a[156:159], a[92:95], v[236:239]
    ds_read_b128 a[144:147], v20 offset:12288
    ds_read_b128 a[148:151], v21 offset:12288
    v_mfma_f32_16x16x32_bf16 a[240:243], a[248:251], v[248:251], a[240:243]
    v_exp_f32 v229, v229
    v_mfma_f32_16x16x32_bf16 a[240:243], a[248:251], v[252:255], a[240:243]
    ds_read_b128 a[152:155], v22 offset:12288
    v_cvt_pk_bf16_f32 v242, v228, v229
    v_mfma_f32_16x16x32_bf16 v[176:179], a[192:195], v[248:251], v[176:179]
    v_exp_f32 v230, v230
    v_mfma_f32_16x16x32_bf16 v[176:179], a[196:199], v[252:255], v[176:179]
    ds_read_b128 a[156:159], v23 offset:12288
    v_mfma_f32_16x16x32_bf16 v[180:183], a[200:203], v[248:251], v[180:183]
    v_exp_f32 v231, v231
    v_mfma_f32_16x16x32_bf16 v[180:183], a[204:207], v[252:255], v[180:183]
    v_cvt_pk_bf16_f32 v243, v230, v231
    v_mfma_f32_16x16x32_bf16 v[184:187], a[208:211], v[248:251], v[184:187]
    v_exp_f32 v232, v232
    v_mfma_f32_16x16x32_bf16 v[184:187], a[212:215], v[252:255], v[184:187]
    v_mfma_f32_16x16x32_bf16 v[188:191], a[216:219], v[248:251], v[188:191]
    v_exp_f32 v233, v233
    v_mfma_f32_16x16x32_bf16 v[188:191], a[220:223], v[252:255], v[188:191]
    v_cvt_pk_bf16_f32 v244, v232, v233
    s_waitcnt lgkmcnt(0)
    v_mfma_f32_16x16x32_bf16 v[160:163], a[160:163], v[248:251], v[160:163]
    v_exp_f32 v234, v234
    v_mfma_f32_16x16x32_bf16 v[160:163], a[164:167], v[252:255], v[160:163]
    v_mfma_f32_16x16x32_bf16 v[164:167], a[168:171], v[248:251], v[164:167]
    v_exp_f32 v235, v235
    v_mfma_f32_16x16x32_bf16 v[164:167], a[172:175], v[252:255], v[164:167]
    v_cvt_pk_bf16_f32 v245, v234, v235
    v_mfma_f32_16x16x32_bf16 v[168:171], a[176:179], v[248:251], v[168:171]
    v_exp_f32 v236, v236
    v_mfma_f32_16x16x32_bf16 v[168:171], a[180:183], v[252:255], v[168:171]
    v_mfma_f32_16x16x32_bf16 v[172:175], a[184:187], v[248:251], v[172:175]
    v_exp_f32 v237, v237
    v_mfma_f32_16x16x32_bf16 v[172:175], a[188:191], v[252:255], v[172:175]
    v_cvt_pk_bf16_f32 v246, v236, v237
    v_mfma_f32_16x16x32_bf16 v[224:227], a[96:99], a[48:51], 0
    v_exp_f32 v238, v238
    v_mfma_f32_16x16x32_bf16 v[224:227], a[100:103], a[52:55], v[224:227]
    v_mfma_f32_16x16x32_bf16 v[224:227], a[104:107], a[56:59], v[224:227]
    v_exp_f32 v239, v239
    v_mfma_f32_16x16x32_bf16 v[224:227], a[108:111], a[60:63], v[224:227]
    v_cvt_pk_bf16_f32 v247, v238, v239
    v_mfma_f32_16x16x32_bf16 v[228:231], a[112:115], a[48:51], 0
    v_mfma_f32_16x16x32_bf16 v[228:231], a[116:119], a[52:55], v[228:231]
    v_mfma_f32_16x16x32_bf16 v[228:231], a[120:123], a[56:59], v[228:231]
    v_exp_f32 v224, v224
    v_mfma_f32_16x16x32_bf16 v[228:231], a[124:127], a[60:63], v[228:231]
    v_mfma_f32_16x16x32_bf16 v[232:235], a[128:131], a[48:51], 0
    v_exp_f32 v225, v225
    v_mfma_f32_16x16x32_bf16 v[232:235], a[132:135], a[52:55], v[232:235]
    v_cvt_pk_bf16_f32 v248, v224, v225
    v_mfma_f32_16x16x32_bf16 v[232:235], a[136:139], a[56:59], v[232:235]
    v_exp_f32 v226, v226
    v_mfma_f32_16x16x32_bf16 v[232:235], a[140:143], a[60:63], v[232:235]
    v_mfma_f32_16x16x32_bf16 v[236:239], a[144:147], a[48:51], 0
    v_exp_f32 v227, v227
    v_mfma_f32_16x16x32_bf16 v[236:239], a[148:151], a[52:55], v[236:239]
    v_cvt_pk_bf16_f32 v249, v226, v227
    v_mfma_f32_16x16x32_bf16 v[236:239], a[152:155], a[56:59], v[236:239]
    v_exp_f32 v228, v228
    v_mfma_f32_16x16x32_bf16 v[236:239], a[156:159], a[60:63], v[236:239]
    v_mfma_f32_16x16x32_bf16 a[244:247], a[248:251], v[240:243], a[244:247]
    v_exp_f32 v229, v229
    v_mfma_f32_16x16x32_bf16 a[244:247], a[248:251], v[244:247], a[244:247]
    v_cvt_pk_bf16_f32 v250, v228, v229
    v_mfma_f32_16x16x32_bf16 v[208:211], a[192:195], v[240:243], v[208:211]
    v_exp_f32 v230, v230
    v_mfma_f32_16x16x32_bf16 v[208:211], a[196:199], v[244:247], v[208:211]
    v_mfma_f32_16x16x32_bf16 v[212:215], a[200:203], v[240:243], v[212:215]
    v_exp_f32 v231, v231
    v_mfma_f32_16x16x32_bf16 v[212:215], a[204:207], v[244:247], v[212:215]
    v_cvt_pk_bf16_f32 v251, v230, v231
    v_mfma_f32_16x16x32_bf16 v[216:219], a[208:211], v[240:243], v[216:219]
    v_exp_f32 v232, v232
    v_mfma_f32_16x16x32_bf16 v[216:219], a[212:215], v[244:247], v[216:219]
    v_mfma_f32_16x16x32_bf16 v[220:223], a[216:219], v[240:243], v[220:223]
    v_exp_f32 v233, v233
    v_mfma_f32_16x16x32_bf16 v[220:223], a[220:223], v[244:247], v[220:223]
    v_cvt_pk_bf16_f32 v252, v232, v233
    v_mfma_f32_16x16x32_bf16 v[192:195], a[160:163], v[240:243], v[192:195]
    v_exp_f32 v234, v234
    v_mfma_f32_16x16x32_bf16 v[192:195], a[164:167], v[244:247], v[192:195]
    ds_read_b64_tr_b16 a[192:193], v28 offset:0
    ds_read_b64_tr_b16 a[194:195], v28 offset:4096
    v_mfma_f32_16x16x32_bf16 v[196:199], a[168:171], v[240:243], v[196:199]
    v_exp_f32 v235, v235
    v_mfma_f32_16x16x32_bf16 v[196:199], a[172:175], v[244:247], v[196:199]
    ds_read_b64_tr_b16 a[196:197], v28 offset:8192
    v_cvt_pk_bf16_f32 v253, v234, v235
    v_mfma_f32_16x16x32_bf16 v[200:203], a[176:179], v[240:243], v[200:203]
    v_exp_f32 v236, v236
    v_mfma_f32_16x16x32_bf16 v[200:203], a[180:183], v[244:247], v[200:203]
    ds_read_b64_tr_b16 a[198:199], v28 offset:12288
    ds_read_b64_tr_b16 a[200:201], v29 offset:0
    v_mfma_f32_16x16x32_bf16 v[204:207], a[184:187], v[240:243], v[204:207]
    v_exp_f32 v237, v237
    v_mfma_f32_16x16x32_bf16 v[204:207], a[188:191], v[244:247], v[204:207]
    ds_read_b64_tr_b16 a[202:203], v29 offset:4096
    v_cvt_pk_bf16_f32 v254, v236, v237
    v_mfma_f32_16x16x32_bf16 v[224:227], a[96:99], a[64:67], 0
    v_exp_f32 v238, v238
    v_mfma_f32_16x16x32_bf16 v[224:227], a[100:103], a[68:71], v[224:227]
    ds_read_b64_tr_b16 a[204:205], v29 offset:8192
    ds_read_b64_tr_b16 a[206:207], v29 offset:12288
    v_mfma_f32_16x16x32_bf16 v[224:227], a[104:107], a[72:75], v[224:227]
    v_exp_f32 v239, v239
    v_mfma_f32_16x16x32_bf16 v[224:227], a[108:111], a[76:79], v[224:227]
    ds_read_b64_tr_b16 a[208:209], v30 offset:0
    v_cvt_pk_bf16_f32 v255, v238, v239
    v_mfma_f32_16x16x32_bf16 v[228:231], a[112:115], a[64:67], 0
    ds_read_b64_tr_b16 a[210:211], v30 offset:4096
    ds_read_b64_tr_b16 a[212:213], v30 offset:8192
    buffer_load_dwordx4 v[48:51], v4, s[32:35], 0 offen sc0 sc1
    v_mfma_f32_16x16x32_bf16 v[228:231], a[116:119], a[68:71], v[228:231]
    ds_read_b64_tr_b16 a[214:215], v30 offset:12288
    ds_read_b64_tr_b16 a[216:217], v31 offset:0
    buffer_load_dwordx4 v[52:55], v4, s[32:35], s56 offen sc0 sc1
    v_mfma_f32_16x16x32_bf16 v[228:231], a[120:123], a[72:75], v[228:231]
    buffer_load_dword v56, v5, s[32:35], s57 offen sc0 sc1
    v_exp_f32 v224, v224
    v_mfma_f32_16x16x32_bf16 v[228:231], a[124:127], a[76:79], v[228:231]
    ds_read_b64_tr_b16 a[218:219], v31 offset:4096
    ds_read_b64_tr_b16 a[220:221], v31 offset:8192
    v_mfma_f32_16x16x32_bf16 v[232:235], a[128:131], a[64:67], 0
    v_exp_f32 v225, v225
    v_mfma_f32_16x16x32_bf16 v[232:235], a[132:135], a[68:71], v[232:235]
    ds_read_b64_tr_b16 a[222:223], v31 offset:12288
    v_cvt_pk_bf16_f32 v240, v224, v225
    v_mfma_f32_16x16x32_bf16 v[232:235], a[136:139], a[72:75], v[232:235]
    v_exp_f32 v226, v226
    v_mfma_f32_16x16x32_bf16 v[232:235], a[140:143], a[76:79], v[232:235]
    ds_read_b64_tr_b16 a[160:161], v24 offset:0
    ds_read_b64_tr_b16 a[162:163], v24 offset:4096
    v_mfma_f32_16x16x32_bf16 v[236:239], a[144:147], a[64:67], 0
    v_exp_f32 v227, v227
    v_mfma_f32_16x16x32_bf16 v[236:239], a[148:151], a[68:71], v[236:239]
    ds_read_b64_tr_b16 a[164:165], v24 offset:8192
    v_cvt_pk_bf16_f32 v241, v226, v227
    v_mfma_f32_16x16x32_bf16 v[236:239], a[152:155], a[72:75], v[236:239]
    v_exp_f32 v228, v228
    s_waitcnt lgkmcnt(7)
    v_mfma_f32_16x16x32_bf16 v[236:239], a[156:159], a[76:79], v[236:239]
    ds_read_b64_tr_b16 a[166:167], v24 offset:12288
    ds_read_b64_tr_b16 a[168:169], v25 offset:0
    v_mfma_f32_16x16x32_bf16 a[236:239], a[248:251], v[248:251], a[236:239]
    v_exp_f32 v229, v229
    v_mfma_f32_16x16x32_bf16 a[236:239], a[248:251], v[252:255], a[236:239]
    ds_read_b64_tr_b16 a[170:171], v25 offset:4096
    v_cvt_pk_bf16_f32 v242, v228, v229
    v_mfma_f32_16x16x32_bf16 v[144:147], a[192:195], v[248:251], v[144:147]
    v_exp_f32 v230, v230
    v_mfma_f32_16x16x32_bf16 v[144:147], a[196:199], v[252:255], v[144:147]
    ds_read_b64_tr_b16 a[172:173], v25 offset:8192
    ds_read_b64_tr_b16 a[174:175], v25 offset:12288
    v_mfma_f32_16x16x32_bf16 v[148:151], a[200:203], v[248:251], v[148:151]
    ds_write_b32 v6, a236 offset:768
    v_exp_f32 v231, v231
    v_mfma_f32_16x16x32_bf16 v[148:151], a[204:207], v[252:255], v[148:151]
    ds_read_b64_tr_b16 a[176:177], v26 offset:0
    ds_read_b64_tr_b16 a[178:179], v26 offset:4096
    v_cvt_pk_bf16_f32 v243, v230, v231
    v_mfma_f32_16x16x32_bf16 v[152:155], a[208:211], v[248:251], v[152:155]
    ds_write_b128 v2, v[144:147] offset:4096
    v_exp_f32 v232, v232
    v_mfma_f32_16x16x32_bf16 v[152:155], a[212:215], v[252:255], v[152:155]
    ds_read_b64_tr_b16 a[180:181], v26 offset:8192
    ds_read_b64_tr_b16 a[182:183], v26 offset:12288
    ds_read_b64_tr_b16 a[184:185], v27 offset:0
    s_waitcnt lgkmcnt(7)
    v_mfma_f32_16x16x32_bf16 v[156:159], a[216:219], v[248:251], v[156:159]
    ds_read_b64_tr_b16 a[186:187], v27 offset:4096
    v_exp_f32 v233, v233
    v_mfma_f32_16x16x32_bf16 v[156:159], a[220:223], v[252:255], v[156:159]
    ds_read_b64_tr_b16 a[188:189], v27 offset:8192
    ds_read_b64_tr_b16 a[190:191], v27 offset:12288
    v_cvt_pk_bf16_f32 v244, v232, v233
    v_mfma_f32_16x16x32_bf16 v[128:131], a[160:163], v[248:251], v[128:131]
    v_exp_f32 v234, v234
    v_mfma_f32_16x16x32_bf16 v[128:131], a[164:167], v[252:255], v[128:131]
    ds_write_b128 v2, v[148:151] offset:5120
    buffer_load_dwordx4 v[80:83], v4, s[32:35], s58 offen sc0 sc1
    v_mfma_f32_16x16x32_bf16 v[132:135], a[168:171], v[248:251], v[132:135]
    buffer_load_dwordx4 v[84:87], v4, s[32:35], s64 offen sc0 sc1
    v_exp_f32 v235, v235
    v_mfma_f32_16x16x32_bf16 v[132:135], a[172:175], v[252:255], v[132:135]
    v_cvt_pk_bf16_f32 v245, v234, v235
    s_waitcnt lgkmcnt(1)
    v_mfma_f32_16x16x32_bf16 v[136:139], a[176:179], v[248:251], v[136:139]
    v_exp_f32 v236, v236
    v_mfma_f32_16x16x32_bf16 v[136:139], a[180:183], v[252:255], v[136:139]
    buffer_load_dword v88, v5, s[32:35], s65 offen sc0 sc1
    v_mfma_f32_16x16x32_bf16 v[140:143], a[184:187], v[248:251], v[140:143]
    ds_write_b128 v2, v[152:155] offset:6144
    v_exp_f32 v237, v237
    v_mfma_f32_16x16x32_bf16 v[140:143], a[188:191], v[252:255], v[140:143]
    v_cvt_pk_bf16_f32 v246, v236, v237
    v_mfma_f32_16x16x32_bf16 v[224:227], a[96:99], a[80:83], 0
    v_exp_f32 v238, v238
    v_mfma_f32_16x16x32_bf16 v[224:227], a[100:103], a[84:87], v[224:227]
    v_mfma_f32_16x16x32_bf16 v[224:227], a[104:107], a[88:91], v[224:227]
    v_exp_f32 v239, v239
    v_mfma_f32_16x16x32_bf16 v[224:227], a[108:111], a[92:95], v[224:227]
    ds_write_b128 v2, v[156:159] offset:7168
    v_cvt_pk_bf16_f32 v247, v238, v239
    v_mfma_f32_16x16x32_bf16 v[228:231], a[112:115], a[80:83], 0
    v_mfma_f32_16x16x32_bf16 v[228:231], a[116:119], a[84:87], v[228:231]
    v_mfma_f32_16x16x32_bf16 v[228:231], a[120:123], a[88:91], v[228:231]
    v_exp_f32 v224, v224
    v_mfma_f32_16x16x32_bf16 v[228:231], a[124:127], a[92:95], v[228:231]
    v_exp_f32 v225, v225
    s_waitcnt lgkmcnt(0)
    s_barrier
    v_mfma_f32_16x16x32_bf16 v[232:235], a[128:131], a[80:83], 0
    ds_read_b64 v[18:19], v7 offset:768
    v_cvt_pk_bf16_f32 v248, v224, v225
    v_exp_f32 v226, v226
    v_mfma_f32_16x16x32_bf16 v[232:235], a[132:135], a[84:87], v[232:235]
    ds_read_b128 v[144:147], v3 offset:4096
    v_exp_f32 v227, v227
    v_mfma_f32_16x16x32_bf16 v[232:235], a[136:139], a[88:91], v[232:235]
    ds_read_b128 v[148:151], v3 offset:5120
    v_cvt_pk_bf16_f32 v249, v226, v227
    v_exp_f32 v228, v228
    v_mfma_f32_16x16x32_bf16 v[232:235], a[140:143], a[92:95], v[232:235]
    ds_read_b128 v[152:155], v3 offset:6144
    v_exp_f32 v229, v229
    v_mfma_f32_16x16x32_bf16 v[236:239], a[144:147], a[80:83], 0
    ds_read_b128 v[156:159], v3 offset:7168
    v_cvt_pk_bf16_f32 v250, v228, v229
    v_exp_f32 v230, v230
    v_mfma_f32_16x16x32_bf16 v[236:239], a[148:151], a[84:87], v[236:239]
    buffer_load_dwordx4 v[112:115], v4, s[32:35], s66 offen sc0 sc1
    v_exp_f32 v231, v231
    v_mfma_f32_16x16x32_bf16 v[236:239], a[152:155], a[88:91], v[236:239]
    v_cvt_pk_bf16_f32 v251, v230, v231
    v_exp_f32 v232, v232
    v_mfma_f32_16x16x32_bf16 v[236:239], a[156:159], a[92:95], v[236:239]
    buffer_load_dwordx4 v[116:119], v4, s[32:35], s61 offen sc0 sc1
    v_exp_f32 v233, v233
    v_mfma_f32_16x16x32_bf16 a[240:243], a[248:251], v[240:243], a[240:243]
    v_cvt_pk_bf16_f32 v252, v232, v233
    v_exp_f32 v234, v234
    v_mfma_f32_16x16x32_bf16 a[240:243], a[248:251], v[244:247], a[240:243]
    buffer_load_dword v120, v5, s[32:35], s62 offen sc0 sc1
    v_exp_f32 v235, v235
    v_mfma_f32_16x16x32_bf16 v[176:179], a[192:195], v[240:243], v[176:179]
    v_cvt_pk_bf16_f32 v253, v234, v235
    v_exp_f32 v236, v236
    v_mfma_f32_16x16x32_bf16 v[176:179], a[196:199], v[244:247], v[176:179]
    v_exp_f32 v237, v237
    s_waitcnt lgkmcnt(4)
    v_mfma_f32_16x16x32_bf16 v[180:183], a[200:203], v[240:243], v[180:183]
    ds_write_b32 v6, a240 offset:1024
    v_cvt_pk_bf16_f32 v254, v236, v237
    v_exp_f32 v238, v238
    v_mfma_f32_16x16x32_bf16 v[180:183], a[204:207], v[244:247], v[180:183]
    v_exp_f32 v239, v239
    v_add_f32 v18, v18, v19
    v_mfma_f32_16x16x32_bf16 v[184:187], a[208:211], v[240:243], v[184:187]
    ds_write_b128 v2, v[176:179] offset:0
    v_cvt_pk_bf16_f32 v255, v238, v239
    s_waitcnt lgkmcnt(4)
    v_mfma_f32_16x16x32_bf16 v[184:187], a[212:215], v[244:247], v[184:187]
    v_add_f32 v128, v128, v144
    v_add_f32 v129, v129, v145
    v_add_f32 v130, v130, v146
    v_mfma_f32_16x16x32_bf16 v[188:191], a[216:219], v[240:243], v[188:191]
    ds_write_b128 v2, v[180:183] offset:1024
    v_add_f32 v131, v131, v147
    v_add_f32 v132, v132, v148
    v_mfma_f32_16x16x32_bf16 v[188:191], a[220:223], v[244:247], v[188:191]
    v_add_f32 v133, v133, v149
    v_add_f32 v134, v134, v150
    v_add_f32 v135, v135, v151
    v_mfma_f32_16x16x32_bf16 v[160:163], a[160:163], v[240:243], v[160:163]
    ds_write_b128 v2, v[184:187] offset:2048
    s_waitcnt lgkmcnt(4)
    v_mfma_f32_16x16x32_bf16 v[160:163], a[164:167], v[244:247], v[160:163]
    v_add_f32 v136, v136, v152
    v_add_f32 v137, v137, v153
    v_add_f32 v138, v138, v154
    v_mfma_f32_16x16x32_bf16 v[164:167], a[168:171], v[240:243], v[164:167]
    ds_write_b128 v2, v[188:191] offset:3072
    v_add_f32 v139, v139, v155
    v_add_f32 v140, v140, v156
    v_mfma_f32_16x16x32_bf16 v[164:167], a[172:175], v[244:247], v[164:167]
    v_add_f32 v141, v141, v157
    v_add_f32 v142, v142, v158
    v_add_f32 v143, v143, v159
    v_mfma_f32_16x16x32_bf16 v[168:171], a[176:179], v[240:243], v[168:171]
    s_waitcnt vmcnt(6)
    v_mfma_f32_16x16x32_bf16 v[168:171], a[180:183], v[244:247], v[168:171]
    v_max3_u32 v57, v48, v49, v50
    v_max3_u32 v57, v57, v51, v52
    v_max3_u32 v57, v57, v53, v54
    v_mfma_f32_16x16x32_bf16 v[172:175], a[184:187], v[240:243], v[172:175]
    v_max3_u32 v57, v57, v55, v56
    s_waitcnt lgkmcnt(0)
    s_barrier
    v_mfma_f32_16x16x32_bf16 v[172:175], a[188:191], v[244:247], v[172:175]
    ds_read_b64 v[20:21], v7 offset:1024
    v_cmp_eq_u32 vcc, -1, v57
    v_mfma_f32_16x16x32_bf16 a[244:247], a[248:251], v[248:251], a[244:247]
    ds_read_b128 v[176:179], v3 offset:0
    s_cbranch_vccnz L_spin0
L_spin0_ret:
    v_mfma_f32_16x16x32_bf16 a[244:247], a[248:251], v[252:255], a[244:247]
    ds_read_b128 v[180:183], v3 offset:1024
    v_add_f32 v18, v18, v56
    v_mfma_f32_16x16x32_bf16 v[208:211], a[192:195], v[248:251], v[208:211]
    ds_read_b128 v[184:187], v3 offset:2048
    v_rcp_f32 v11, v18
    v_mfma_f32_16x16x32_bf16 v[208:211], a[196:199], v[252:255], v[208:211]
    ds_read_b128 v[188:191], v3 offset:3072
    v_dot2c_f32_bf16 v128, s52, v48
    v_dot2c_f32_bf16 v129, s53, v48
    v_mfma_f32_16x16x32_bf16 v[212:215], a[200:203], v[248:251], v[212:215]
    ds_write_b32 v6, a244 offset:1280
    v_dot2c_f32_bf16 v130, s52, v49
    v_dot2c_f32_bf16 v131, s53, v49
    v_mfma_f32_16x16x32_bf16 v[212:215], a[204:207], v[252:255], v[212:215]
    v_dot2c_f32_bf16 v132, s52, v50
    v_dot2c_f32_bf16 v133, s53, v50
    v_dot2c_f32_bf16 v134, s52, v51
    v_mfma_f32_16x16x32_bf16 v[216:219], a[208:211], v[248:251], v[216:219]
    ds_write_b128 v2, v[208:211] offset:4096
    v_dot2c_f32_bf16 v135, s53, v51
    v_dot2c_f32_bf16 v136, s52, v52
    v_mfma_f32_16x16x32_bf16 v[216:219], a[212:215], v[252:255], v[216:219]
    v_dot2c_f32_bf16 v137, s53, v52
    v_dot2c_f32_bf16 v138, s52, v53
    v_dot2c_f32_bf16 v139, s53, v53
    v_mfma_f32_16x16x32_bf16 v[220:223], a[216:219], v[248:251], v[220:223]
    ds_write_b128 v2, v[212:215] offset:5120
    v_dot2c_f32_bf16 v140, s52, v54
    v_dot2c_f32_bf16 v141, s53, v54
    v_mfma_f32_16x16x32_bf16 v[220:223], a[220:223], v[252:255], v[220:223]
    v_dot2c_f32_bf16 v142, s52, v55
    v_dot2c_f32_bf16 v143, s53, v55
    v_max3_f32 v9, v9, v18, v11
    v_mfma_f32_16x16x32_bf16 v[192:195], a[160:163], v[248:251], v[192:195]
    ds_write_b128 v2, v[216:219] offset:6144
    v_mul_f32 v128, v128, v11
    v_mul_f32 v129, v129, v11
    v_mfma_f32_16x16x32_bf16 v[192:195], a[164:167], v[252:255], v[192:195]
    v_mul_f32 v130, v130, v11
    v_mul_f32 v131, v131, v11
    v_mul_f32 v132, v132, v11
    v_mfma_f32_16x16x32_bf16 v[196:199], a[168:171], v[248:251], v[196:199]
    ds_write_b128 v2, v[220:223] offset:7168
    v_mul_f32 v133, v133, v11
    v_mul_f32 v134, v134, v11
    v_mfma_f32_16x16x32_bf16 v[196:199], a[172:175], v[252:255], v[196:199]
    v_mul_f32 v135, v135, v11
    v_cvt_pk_bf16_f32 v128, v128, v129
    v_cvt_pk_bf16_f32 v129, v130, v131
    v_mfma_f32_16x16x32_bf16 v[200:203], a[176:179], v[248:251], v[200:203]
    v_cvt_pk_bf16_f32 v130, v132, v133
    v_cvt_pk_bf16_f32 v131, v134, v135
    s_mov_b32 s51, 0
    v_mfma_f32_16x16x32_bf16 v[200:203], a[180:183], v[252:255], v[200:203]
    v_permlane16_swap_b32 v128, v130
    v_mfma_f32_16x16x32_bf16 v[204:207], a[184:187], v[248:251], v[204:207]
    s_waitcnt lgkmcnt(0)
    s_barrier
    v_mfma_f32_16x16x32_bf16 v[204:207], a[188:191], v[252:255], v[204:207]
    v_permlane16_swap_b32 v129, v131
    ds_read_b64 v[22:23], v7 offset:1280
    ds_read_b128 v[208:211], v3 offset:4096
    ds_read_b128 v[212:215], v3 offset:5120
    ds_read_b128 v[216:219], v3 offset:6144
    ds_read_b128 v[220:223], v3 offset:7168
    buffer_store_dwordx4 v[128:131], v8, s[20:23], s51 offen offset:0 sc0 sc1 nt
    v_mul_f32 v136, v136, v11
    v_mul_f32 v137, v137, v11
    v_mul_f32 v138, v138, v11
    v_mul_f32 v139, v139, v11
    v_mul_f32 v140, v140, v11
    v_mul_f32 v141, v141, v11
    v_mul_f32 v142, v142, v11
    v_mul_f32 v143, v143, v11
    v_cvt_pk_bf16_f32 v136, v136, v137
    v_cvt_pk_bf16_f32 v137, v138, v139
    v_cvt_pk_bf16_f32 v138, v140, v141
    v_cvt_pk_bf16_f32 v139, v142, v143
    s_mov_b32 s51, 0
    v_permlane16_swap_b32 v136, v138
    v_permlane16_swap_b32 v137, v139
    buffer_store_dwordx4 v[136:139], v8, s[20:23], s51 offen offset:64 sc0 sc1 nt
    s_waitcnt lgkmcnt(14)
    v_add_f32 v20, v20, v21
    s_waitcnt lgkmcnt(12)
    v_pk_add_f32 v[160:161], v[160:161], v[176:177]
    v_pk_add_f32 v[162:163], v[162:163], v[178:179]
    v_pk_add_f32 v[164:165], v[164:165], v[180:181]
    v_pk_add_f32 v[166:167], v[166:167], v[182:183]
    s_waitcnt lgkmcnt(10)
    v_pk_add_f32 v[168:169], v[168:169], v[184:185]
    v_pk_add_f32 v[170:171], v[170:171], v[186:187]
    v_pk_add_f32 v[172:173], v[172:173], v[188:189]
    v_pk_add_f32 v[174:175], v[174:175], v[190:191]
    s_waitcnt vmcnt(5)
    v_max3_u32 v89, v80, v81, v82
    v_max3_u32 v89, v89, v83, v84
    v_max3_u32 v89, v89, v85, v86
    v_max3_u32 v89, v89, v87, v88
    v_cmp_eq_u32 vcc, -1, v89
    s_cbranch_vccnz L_spin1
L_spin1_ret:
    v_add_f32 v20, v20, v88
    v_rcp_f32 v10, v20
    v_dot2c_f32_bf16 v160, s52, v80
    v_dot2c_f32_bf16 v161, s53, v80
    v_dot2c_f32_bf16 v162, s52, v81
    v_dot2c_f32_bf16 v163, s53, v81
    v_dot2c_f32_bf16 v164, s52, v82
    v_dot2c_f32_bf16 v165, s53, v82
    v_dot2c_f32_bf16 v166, s52, v83
    v_dot2c_f32_bf16 v167, s53, v83
    v_dot2c_f32_bf16 v168, s52, v84
    v_dot2c_f32_bf16 v169, s53, v84
    v_dot2c_f32_bf16 v170, s52, v85
    v_dot2c_f32_bf16 v171, s53, v85
    v_dot2c_f32_bf16 v172, s52, v86
    v_dot2c_f32_bf16 v173, s53, v86
    v_dot2c_f32_bf16 v174, s52, v87
    v_dot2c_f32_bf16 v175, s53, v87
    v_max3_f32 v9, v9, v20, v10
    v_pk_mul_f32 v[160:161], v[160:161], v[10:11] op_sel:[0,0] op_sel_hi:[1,0]
    v_pk_mul_f32 v[162:163], v[162:163], v[10:11] op_sel:[0,0] op_sel_hi:[1,0]
    v_pk_mul_f32 v[164:165], v[164:165], v[10:11] op_sel:[0,0] op_sel_hi:[1,0]
    v_pk_mul_f32 v[166:167], v[166:167], v[10:11] op_sel:[0,0] op_sel_hi:[1,0]
    v_cvt_pk_bf16_f32 v160, v160, v161
    v_cvt_pk_bf16_f32 v161, v162, v163
    v_cvt_pk_bf16_f32 v162, v164, v165
    v_cvt_pk_bf16_f32 v163, v166, v167
    s_mov_b32 s51, 4096
    v_permlane16_swap_b32 v160, v162
    v_permlane16_swap_b32 v161, v163
    buffer_store_dwordx4 v[160:163], v8, s[20:23], s51 offen offset:0 sc0 sc1 nt
    v_pk_mul_f32 v[168:169], v[168:169], v[10:11] op_sel:[0,0] op_sel_hi:[1,0]
    v_pk_mul_f32 v[170:171], v[170:171], v[10:11] op_sel:[0,0] op_sel_hi:[1,0]
    v_pk_mul_f32 v[172:173], v[172:173], v[10:11] op_sel:[0,0] op_sel_hi:[1,0]
    v_pk_mul_f32 v[174:175], v[174:175], v[10:11] op_sel:[0,0] op_sel_hi:[1,0]
    v_cvt_pk_bf16_f32 v168, v168, v169
    v_cvt_pk_bf16_f32 v169, v170, v171
    v_cvt_pk_bf16_f32 v170, v172, v173
    v_cvt_pk_bf16_f32 v171, v174, v175
    s_mov_b32 s51, 4096
    v_permlane16_swap_b32 v168, v170
    v_permlane16_swap_b32 v169, v171
    buffer_store_dwordx4 v[168:171], v8, s[20:23], s51 offen offset:64 sc0 sc1 nt
    s_waitcnt lgkmcnt(4)
    v_add_f32 v22, v22, v23
    s_waitcnt lgkmcnt(2)
    v_pk_add_f32 v[192:193], v[192:193], v[208:209]
    v_pk_add_f32 v[194:195], v[194:195], v[210:211]
    v_pk_add_f32 v[196:197], v[196:197], v[212:213]
    v_pk_add_f32 v[198:199], v[198:199], v[214:215]
    s_waitcnt lgkmcnt(0)
    v_pk_add_f32 v[200:201], v[200:201], v[216:217]
    v_pk_add_f32 v[202:203], v[202:203], v[218:219]
    v_pk_add_f32 v[204:205], v[204:205], v[220:221]
    v_pk_add_f32 v[206:207], v[206:207], v[222:223]
    s_waitcnt vmcnt(4)
    v_max3_u32 v121, v112, v113, v114
    v_max3_u32 v121, v121, v115, v116
    v_max3_u32 v121, v121, v117, v118
    v_max3_u32 v121, v121, v119, v120
    v_cmp_eq_u32 vcc, -1, v121
    s_cbranch_vccnz L_spin2
L_spin2_ret:
    v_add_f32 v22, v22, v120
    v_rcp_f32 v11, v22
    v_dot2c_f32_bf16 v192, s52, v112
    v_dot2c_f32_bf16 v193, s53, v112
    v_dot2c_f32_bf16 v194, s52, v113
    v_dot2c_f32_bf16 v195, s53, v113
    v_dot2c_f32_bf16 v196, s52, v114
    v_dot2c_f32_bf16 v197, s53, v114
    v_dot2c_f32_bf16 v198, s52, v115
    v_dot2c_f32_bf16 v199, s53, v115
    v_dot2c_f32_bf16 v200, s52, v116
    v_dot2c_f32_bf16 v201, s53, v116
    v_dot2c_f32_bf16 v202, s52, v117
    v_dot2c_f32_bf16 v203, s53, v117
    v_dot2c_f32_bf16 v204, s52, v118
    v_dot2c_f32_bf16 v205, s53, v118
    v_dot2c_f32_bf16 v206, s52, v119
    v_dot2c_f32_bf16 v207, s53, v119
    v_max3_f32 v9, v9, v22, v11
    v_pk_mul_f32 v[192:193], v[192:193], v[10:11] op_sel:[0,1] op_sel_hi:[1,1]
    v_pk_mul_f32 v[194:195], v[194:195], v[10:11] op_sel:[0,1] op_sel_hi:[1,1]
    v_pk_mul_f32 v[196:197], v[196:197], v[10:11] op_sel:[0,1] op_sel_hi:[1,1]
    v_pk_mul_f32 v[198:199], v[198:199], v[10:11] op_sel:[0,1] op_sel_hi:[1,1]
    v_cvt_pk_bf16_f32 v192, v192, v193
    v_cvt_pk_bf16_f32 v193, v194, v195
    v_cvt_pk_bf16_f32 v194, v196, v197
    v_cvt_pk_bf16_f32 v195, v198, v199
    s_mov_b32 s51, 8192
    v_permlane16_swap_b32 v192, v194
    v_permlane16_swap_b32 v193, v195
    buffer_store_dwordx4 v[192:195], v8, s[20:23], s51 offen offset:0 sc0 sc1 nt
    v_pk_mul_f32 v[200:201], v[200:201], v[10:11] op_sel:[0,1] op_sel_hi:[1,1]
    v_pk_mul_f32 v[202:203], v[202:203], v[10:11] op_sel:[0,1] op_sel_hi:[1,1]
    v_pk_mul_f32 v[204:205], v[204:205], v[10:11] op_sel:[0,1] op_sel_hi:[1,1]
    v_pk_mul_f32 v[206:207], v[206:207], v[10:11] op_sel:[0,1] op_sel_hi:[1,1]
    v_cvt_pk_bf16_f32 v200, v200, v201
    v_cvt_pk_bf16_f32 v201, v202, v203
    v_cvt_pk_bf16_f32 v202, v204, v205
    v_cvt_pk_bf16_f32 v203, v206, v207
    s_mov_b32 s51, 8192
    v_permlane16_swap_b32 v200, v202
    v_permlane16_swap_b32 v201, v203
    buffer_store_dwordx4 v[200:203], v8, s[20:23], s51 offen offset:64 sc0 sc1 nt
    s_mov_b32 s51, 0x53800000
    v_cmp_nge_f32 vcc, s51, v9
    s_cbranch_vccnz L_fallback
L_fin:
L_end:
    s_endpgm
L_spinf:
    buffer_load_dword v10, off, s[44:47], s59 sc0 sc1
    s_add_u32 s67, s67, 1
    s_waitcnt vmcnt(0)
    v_and_b32 v10, s73, v10
    v_cmp_eq_u32 vcc, 0, v10
    s_cbranch_vccz L_spinf_ret
    s_cmp_lt_u32 s67, 3000
    s_cbranch_scc1 L_spinf
    v_mov_b32 v9, 0x7f800000
    s_branch L_spinf_ret
L_spin0:
    buffer_load_dwordx4 v[48:51], v4, s[32:35], 0 offen sc0 sc1
    buffer_load_dwordx4 v[52:55], v4, s[32:35], s56 offen sc0 sc1
    buffer_load_dword v56, v5, s[32:35], s57 offen sc0 sc1
    s_add_u32 s67, s67, 1
    s_waitcnt vmcnt(0)
    v_max3_u32 v57, v48, v49, v50
    v_max3_u32 v57, v57, v51, v52
    v_max3_u32 v57, v57, v53, v54
    v_max3_u32 v57, v57, v55, v56
    v_cmp_eq_u32 vcc, -1, v57
    s_cbranch_vccz L_spin0_ret
    s_cmp_lt_u32 s67, 3000
    s_cbranch_scc1 L_spin0
    v_mov_b32 v9, 0x7f800000
    s_branch L_spin0_ret
L_spin1:
    buffer_load_dwordx4 v[80:83], v4, s[32:35], s58 offen sc0 sc1
    buffer_load_dwordx4 v[84:87], v4, s[32:35], s64 offen sc0 sc1
    buffer_load_dword v88, v5, s[32:35], s65 offen sc0 sc1
    s_add_u32 s67, s67, 1
    s_waitcnt vmcnt(0)
    v_max3_u32 v89, v80, v81, v82
    v_max3_u32 v89, v89, v83, v84
    v_max3_u32 v89, v89, v85, v86
    v_max3_u32 v89, v89, v87, v88
    v_cmp_eq_u32 vcc, -1, v89
    s_cbranch_vccz L_spin1_ret
    s_cmp_lt_u32 s67, 3000
    s_cbranch_scc1 L_spin1
    v_mov_b32 v9, 0x7f800000
    s_branch L_spin1_ret
L_spin2:
    buffer_load_dwordx4 v[112:115], v4, s[32:35], s66 offen sc0 sc1
    buffer_load_dwordx4 v[116:119], v4, s[32:35], s61 offen sc0 sc1
    buffer_load_dword v120, v5, s[32:35], s62 offen sc0 sc1
    s_add_u32 s67, s67, 1
    s_waitcnt vmcnt(0)
    v_max3_u32 v121, v112, v113, v114
    v_max3_u32 v121, v121, v115, v116
    v_max3_u32 v121, v121, v117, v118
    v_max3_u32 v121, v121, v119, v120
    v_cmp_eq_u32 vcc, -1, v121
    s_cbranch_vccz L_spin2_ret
    s_cmp_lt_u32 s67, 3000
    s_cbranch_scc1 L_spin2
    v_mov_b32 v9, 0x7f800000
    s_branch L_spin2_ret
L_fallback:
    s_waitcnt vmcnt(0) lgkmcnt(0)
    s_lshl_b32 s51, s50, 14
    s_add_u32 s48, s48, s51
    s_lshl_b32 s51, s49, 7
    s_add_u32 s12, s6, s72
    s_addc_u32 s13, s7, 0
    s_add_u32 s16, s40, s72
    s_addc_u32 s17, s41, 0
    s_mov_b32 s14, 0x80000
    s_mov_b32 s18, 0x80000
    v_lshrrev_b32 v224, 4, v1
    v_and_b32 v225, 15, v1
    v_xor_b32 v226, v225, v224
    v_lshlrev_b32 v227, 8, v224
    v_lshl_add_u32 v12, v226, 4, v227
    v_xor_b32 v13, 64, v12
    v_xor_b32 v14, 128, v12
    v_xor_b32 v15, 192, v12
    v_lshlrev_b32 v229, 8, v225
    v_lshl_add_u32 v229, v226, 4, v229
    v_add_u32 v20, s48, v229
    v_lshlrev_b32 v226, 1, v224
    v_xor_b32 v226, v225, v226
    v_lshl_add_u32 v16, v226, 4, v227
    v_xor_b32 v17, 0x80, v16
    v_xor_b32 v21, 64, v20
    v_xor_b32 v22, 128, v20
    v_xor_b32 v23, 192, v20
    v_lshrrev_b32 v226, 2, v1
    v_and_b32 v227, 7, v226
    v_lshlrev_b32 v227, 5, v227
    v_xor_b32 v227, s51, v227
    v_lshl_add_u32 v227, v226, 8, v227
    v_and_b32 v226, 3, v1
    v_lshl_add_u32 v227, v226, 3, v227
    v_add_u32 v24, s48, v227
    v_xor_b32 v25, 32, v24
    v_xor_b32 v26, 64, v24
    v_xor_b32 v27, 96, v24
    v_xor_b32 v28, 128, v24
    v_xor_b32 v29, 160, v24
    v_xor_b32 v30, 192, v24
    v_xor_b32 v31, 224, v24
    s_add_u32 s60, s48, 0
    s_add_u32 s61, s48, 4096
    s_add_u32 s62, s48, 8192
    s_add_u32 s63, s48, 12288
    v_mov_b32 v248, 0xff800000
    v_mov_b32 v249, 0xff800000
    v_mov_b32 v250, 0xff800000
    s_mov_b32 s24, 0
    s_mov_b32 s25, 4096
    s_mov_b32 s26, 8192
    s_mov_b32 s27, 12288
    s_mov_b32 s38, 0
L_fb1:
    s_mov_b32 m0, s60
    s_nop 0
    buffer_load_dwordx4 v12, s[12:15], s24 offen offset:0 nt lds
    buffer_load_dwordx4 v13, s[12:15], s24 offen offset:1024 nt lds
    buffer_load_dwordx4 v14, s[12:15], s24 offen offset:2048 nt lds
    buffer_load_dwordx4 v15, s[12:15], s24 offen offset:3072 nt lds
    s_mov_b32 m0, s61
    s_nop 0
    buffer_load_dwordx4 v12, s[12:15], s25 offen offset:0 nt lds
    buffer_load_dwordx4 v13, s[12:15], s25 offen offset:1024 nt lds
    buffer_load_dwordx4 v14, s[12:15], s25 offen offset:2048 nt lds
    buffer_load_dwordx4 v15, s[12:15], s25 offen offset:3072 nt lds
    s_mov_b32 m0, s62
    s_nop 0
    buffer_load_dwordx4 v12, s[12:15], s26 offen offset:0 nt lds
    buffer_load_dwordx4 v13, s[12:15], s26 offen offset:1024 nt lds
    buffer_load_dwordx4 v14, s[12:15], s26 offen offset:2048 nt lds
    buffer_load_dwordx4 v15, s[12:15], s26 offen offset:3072 nt lds
    s_mov_b32 m0, s63
    s_nop 0
    buffer_load_dwordx4 v12, s[12:15], s27 offen offset:0 nt lds
    buffer_load_dwordx4 v13, s[12:15], s27 offen offset:1024 nt lds
    buffer_load_dwordx4 v14, s[12:15], s27 offen offset:2048 nt lds
    buffer_load_dwordx4 v15, s[12:15], s27 offen offset:3072 nt lds
    s_waitcnt vmcnt(0)
    ds_read_b128 a[96:99], v20 offset:0
    ds_read_b128 a[100:103], v21 offset:0
    ds_read_b128 a[104:107], v22 offset:0
    ds_read_b128 a[108:111], v23 offset:0
    ds_read_b128 a[112:115], v20 offset:4096
    ds_read_b128 a[116:119], v21 offset:4096
    ds_read_b128 a[120:123], v22 offset:4096
    ds_read_b128 a[124:127], v23 offset:4096
    ds_read_b128 a[128:131], v20 offset:8192
    ds_read_b128 a[132:135], v21 offset:8192
    ds_read_b128 a[136:139], v22 offset:8192
    ds_read_b128 a[140:143], v23 offset:8192
    ds_read_b128 a[144:147], v20 offset:12288
    ds_read_b128 a[148:151], v21 offset:12288
    ds_read_b128 a[152:155], v22 offset:12288
    ds_read_b128 a[156:159], v23 offset:12288
    s_waitcnt lgkmcnt(0)
    v_mfma_f32_16x16x32_bf16 v[224:227], a[96:99], a[48:51], 0
    v_mfma_f32_16x16x32_bf16 v[224:227], a[100:103], a[52:55], v[224:227]
    v_mfma_f32_16x16x32_bf16 v[224:227], a[104:107], a[56:59], v[224:227]
    v_mfma_f32_16x16x32_bf16 v[224:227], a[108:111], a[60:63], v[224:227]
    v_mfma_f32_16x16x32_bf16 v[228:231], a[112:115], a[48:51], 0
    v_mfma_f32_16x16x32_bf16 v[228:231], a[116:119], a[52:55], v[228:231]
    v_mfma_f32_16x16x32_bf16 v[228:231], a[120:123], a[56:59], v[228:231]
    v_mfma_f32_16x16x32_bf16 v[228:231], a[124:127], a[60:63], v[228:231]
    v_mfma_f32_16x16x32_bf16 v[232:235], a[128:131], a[48:51], 0
    v_mfma_f32_16x16x32_bf16 v[232:235], a[132:135], a[52:55], v[232:235]
    v_mfma_f32_16x16x32_bf16 v[232:235], a[136:139], a[56:59], v[232:235]
    v_mfma_f32_16x16x32_bf16 v[232:235], a[140:143], a[60:63], v[232:235]
    v_mfma_f32_16x16x32_bf16 v[236:239], a[144:147], a[48:51], 0
    v_mfma_f32_16x16x32_bf16 v[236:239], a[148:151], a[52:55], v[236:239]
    v_mfma_f32_16x16x32_bf16 v[236:239], a[152:155], a[56:59], v[236:239]
    v_mfma_f32_16x16x32_bf16 v[236:239], a[156:159], a[60:63], v[236:239]
    s_nop 9
    v_max3_f32 v248, v224, v225, v248
    v_max3_f32 v248, v226, v227, v248
    v_max3_f32 v248, v228, v229, v248
    v_max3_f32 v248, v230, v231, v248
    v_max3_f32 v248, v232, v233, v248
    v_max3_f32 v248, v234, v235, v248
    v_max3_f32 v248, v236, v237, v248
    v_max3_f32 v248, v238, v239, v248
    v_mfma_f32_16x16x32_bf16 v[224:227], a[96:99], a[64:67], 0
    v_mfma_f32_16x16x32_bf16 v[224:227], a[100:103], a[68:71], v[224:227]
    v_mfma_f32_16x16x32_bf16 v[224:227], a[104:107], a[72:75], v[224:227]
    v_mfma_f32_16x16x32_bf16 v[224:227], a[108:111], a[76:79], v[224:227]
    v_mfma_f32_16x16x32_bf16 v[228:231], a[112:115], a[64:67], 0
    v_mfma_f32_16x16x32_bf16 v[228:231], a[116:119], a[68:71], v[228:231]
    v_mfma_f32_16x16x32_bf16 v[228:231], a[120:123], a[72:75], v[228:231]
    v_mfma_f32_16x16x32_bf16 v[228:231], a[124:127], a[76:79], v[228:231]
    v_mfma_f32_16x16x32_bf16 v[232:235], a[128:131], a[64:67], 0
    v_mfma_f32_16x16x32_bf16 v[232:235], a[132:135], a[68:71], v[232:235]
    v_mfma_f32_16x16x32_bf16 v[232:235], a[136:139], a[72:75], v[232:235]
    v_mfma_f32_16x16x32_bf16 v[232:235], a[140:143], a[76:79], v[232:235]
    v_mfma_f32_16x16x32_bf16 v[236:239], a[144:147], a[64:67], 0
    v_mfma_f32_16x16x32_bf16 v[236:239], a[148:151], a[68:71], v[236:239]
    v_mfma_f32_16x16x32_bf16 v[236:239], a[152:155], a[72:75], v[236:239]
    v_mfma_f32_16x16x32_bf16 v[236:239], a[156:159], a[76:79], v[236:239]
    s_nop 9
    v_max3_f32 v249, v224, v225, v249
    v_max3_f32 v249, v226, v227, v249
    v_max3_f32 v249, v228, v229, v249
    v_max3_f32 v249, v230, v231, v249
    v_max3_f32 v249, v232, v233, v249
    v_max3_f32 v249, v234, v235, v249
    v_max3_f32 v249, v236, v237, v249
    v_max3_f32 v249, v238, v239, v249
    v_mfma_f32_16x16x32_bf16 v[224:227], a[96:99], a[80:83], 0
    v_mfma_f32_16x16x32_bf16 v[224:227], a[100:103], a[84:87], v[224:227]
    v_mfma_f32_16x16x32_bf16 v[224:227], a[104:107], a[88:91], v[224:227]
    v_mfma_f32_16x16x32_bf16 v[224:227], a[108:111], a[92:95], v[224:227]
    v_mfma_f32_16x16x32_bf16 v[228:231], a[112:115], a[80:83], 0
    v_mfma_f32_16x16x32_bf16 v[228:231], a[116:119], a[84:87], v[228:231]
    v_mfma_f32_16x16x32_bf16 v[228:231], a[120:123], a[88:91], v[228:231]
    v_mfma_f32_16x16x32_bf16 v[228:231], a[124:127], a[92:95], v[228:231]
    v_mfma_f32_16x16x32_bf16 v[232:235], a[128:131], a[80:83], 0
    v_mfma_f32_16x16x32_bf16 v[232:235], a[132:135], a[84:87], v[232:235]
    v_mfma_f32_16x16x32_bf16 v[232:235], a[136:139], a[88:91], v[232:235]
    v_mfma_f32_16x16x32_bf16 v[232:235], a[140:143], a[92:95], v[232:235]
    v_mfma_f32_16x16x32_bf16 v[236:239], a[144:147], a[80:83], 0
    v_mfma_f32_16x16x32_bf16 v[236:239], a[148:151], a[84:87], v[236:239]
    v_mfma_f32_16x16x32_bf16 v[236:239], a[152:155], a[88:91], v[236:239]
    v_mfma_f32_16x16x32_bf16 v[236:239], a[156:159], a[92:95], v[236:239]
    s_nop 9
    v_max3_f32 v250, v224, v225, v250
    v_max3_f32 v250, v226, v227, v250
    v_max3_f32 v250, v228, v229, v250
    v_max3_f32 v250, v230, v231, v250
    v_max3_f32 v250, v232, v233, v250
    v_max3_f32 v250, v234, v235, v250
    v_max3_f32 v250, v236, v237, v250
    v_max3_f32 v250, v238, v239, v250
    s_add_u32 s24, s24, 16384
    s_add_u32 s25, s25, 16384
    s_add_u32 s26, s26, 16384
    s_add_u32 s27, s27, 16384
    s_add_u32 s38, s38, 1
    s_cmp_lt_u32 s38, 32
    s_cbranch_scc1 L_fb1
    v_mov_b32 v224, v248
    s_nop 1
    v_permlane32_swap_b32 v224, v248
    s_nop 1
    v_max_f32 v248, v224, v248
    v_mov_b32 v224, v248
    s_nop 1
    v_permlane16_swap_b32 v224, v248
    s_nop 1
    v_max_f32 v248, v224, v248
    v_mov_b32 v128, 0
    v_mov_b32 v129, 0
    v_mov_b32 v130, 0
    v_mov_b32 v131, 0
    v_mov_b32 v132, 0
    v_mov_b32 v133, 0
    v_mov_b32 v134, 0
    v_mov_b32 v135, 0
    v_mov_b32 v136, 0
    v_mov_b32 v137, 0
    v_mov_b32 v138, 0
    v_mov_b32 v139, 0
    v_mov_b32 v140, 0
    v_mov_b32 v141, 0
    v_mov_b32 v142, 0
    v_mov_b32 v143, 0
    v_accvgpr_write_b32 a236, 0
    v_accvgpr_write_b32 a237, 0
    v_accvgpr_write_b32 a238, 0
    v_accvgpr_write_b32 a239, 0
    v_mov_b32 v224, v249
    s_nop 1
    v_permlane32_swap_b32 v224, v249
    s_nop 1
    v_max_f32 v249, v224, v249
    v_mov_b32 v224, v249
    s_nop 1
    v_permlane16_swap_b32 v224, v249
    s_nop 1
    v_max_f32 v249, v224, v249
    v_mov_b32 v160, 0
    v_mov_b32 v161, 0
    v_mov_b32 v162, 0
    v_mov_b32 v163, 0
    v_mov_b32 v164, 0
    v_mov_b32 v165, 0
    v_mov_b32 v166, 0
    v_mov_b32 v167, 0
    v_mov_b32 v168, 0
    v_mov_b32 v169, 0
    v_mov_b32 v170, 0
    v_mov_b32 v171, 0
    v_mov_b32 v172, 0
    v_mov_b32 v173, 0
    v_mov_b32 v174, 0
    v_mov_b32 v175, 0
    v_accvgpr_write_b32 a240, 0
    v_accvgpr_write_b32 a241, 0
    v_accvgpr_write_b32 a242, 0
    v_accvgpr_write_b32 a243, 0
    v_mov_b32 v224, v250
    s_nop 1
    v_permlane32_swap_b32 v224, v250
    s_nop 1
    v_max_f32 v250, v224, v250
    v_mov_b32 v224, v250
    s_nop 1
    v_permlane16_swap_b32 v224, v250
    s_nop 1
    v_max_f32 v250, v224, v250
    v_mov_b32 v192, 0
    v_mov_b32 v193, 0
    v_mov_b32 v194, 0
    v_mov_b32 v195, 0
    v_mov_b32 v196, 0
    v_mov_b32 v197, 0
    v_mov_b32 v198, 0
    v_mov_b32 v199, 0
    v_mov_b32 v200, 0
    v_mov_b32 v201, 0
    v_mov_b32 v202, 0
    v_mov_b32 v203, 0
    v_mov_b32 v204, 0
    v_mov_b32 v205, 0
    v_mov_b32 v206, 0
    v_mov_b32 v207, 0
    v_accvgpr_write_b32 a244, 0
    v_accvgpr_write_b32 a245, 0
    v_accvgpr_write_b32 a246, 0
    v_accvgpr_write_b32 a247, 0
    s_mov_b32 s24, 0
    s_mov_b32 s25, 4096
    s_mov_b32 s26, 8192
    s_mov_b32 s27, 12288
    s_mov_b32 s38, 0
L_fb2:
    s_mov_b32 m0, s60
    s_nop 0
    buffer_load_dwordx4 v12, s[12:15], s24 offen offset:0 nt lds
    buffer_load_dwordx4 v13, s[12:15], s24 offen offset:1024 nt lds
    buffer_load_dwordx4 v14, s[12:15], s24 offen offset:2048 nt lds
    buffer_load_dwordx4 v15, s[12:15], s24 offen offset:3072 nt lds
    s_mov_b32 m0, s61
    s_nop 0
    buffer_load_dwordx4 v12, s[12:15], s25 offen offset:0 nt lds
    buffer_load_dwordx4 v13, s[12:15], s25 offen offset:1024 nt lds
    buffer_load_dwordx4 v14, s[12:15], s25 offen offset:2048 nt lds
    buffer_load_dwordx4 v15, s[12:15], s25 offen offset:3072 nt lds
    s_mov_b32 m0, s62
    s_nop 0
    buffer_load_dwordx4 v12, s[12:15], s26 offen offset:0 nt lds
    buffer_load_dwordx4 v13, s[12:15], s26 offen offset:1024 nt lds
    buffer_load_dwordx4 v14, s[12:15], s26 offen offset:2048 nt lds
    buffer_load_dwordx4 v15, s[12:15], s26 offen offset:3072 nt lds
    s_mov_b32 m0, s63
    s_nop 0
    buffer_load_dwordx4 v12, s[12:15], s27 offen offset:0 nt lds
    buffer_load_dwordx4 v13, s[12:15], s27 offen offset:1024 nt lds
    buffer_load_dwordx4 v14, s[12:15], s27 offen offset:2048 nt lds
    buffer_load_dwordx4 v15, s[12:15], s27 offen offset:3072 nt lds
    s_waitcnt vmcnt(0)
    ds_read_b128 a[96:99], v20 offset:0
    ds_read_b128 a[100:103], v21 offset:0
    ds_read_b128 a[104:107], v22 offset:0
    ds_read_b128 a[108:111], v23 offset:0
    ds_read_b128 a[112:115], v20 offset:4096
    ds_read_b128 a[116:119], v21 offset:4096
    ds_read_b128 a[120:123], v22 offset:4096
    ds_read_b128 a[124:127], v23 offset:4096
    ds_read_b128 a[128:131], v20 offset:8192
    ds_read_b128 a[132:135], v21 offset:8192
    ds_read_b128 a[136:139], v22 offset:8192
    ds_read_b128 a[140:143], v23 offset:8192
    ds_read_b128 a[144:147], v20 offset:12288
    ds_read_b128 a[148:151], v21 offset:12288
    ds_read_b128 a[152:155], v22 offset:12288
    ds_read_b128 a[156:159], v23 offset:12288
    s_waitcnt lgkmcnt(0)
    s_mov_b32 m0, s60
    s_nop 0
    buffer_load_dwordx4 v16, s[16:19], s24 offen offset:0 nt lds
    buffer_load_dwordx4 v17, s[16:19], s24 offen offset:1024 nt lds
    buffer_load_dwordx4 v16, s[16:19], s24 offen offset:2048 nt lds
    buffer_load_dwordx4 v17, s[16:19], s24 offen offset:3072 nt lds
    s_mov_b32 m0, s61
    s_nop 0
    buffer_load_dwordx4 v16, s[16:19], s25 offen offset:0 nt lds
    buffer_load_dwordx4 v17, s[16:19], s25 offen offset:1024 nt lds
    buffer_load_dwordx4 v16, s[16:19], s25 offen offset:2048 nt lds
    buffer_load_dwordx4 v17, s[16:19], s25 offen offset:3072 nt lds
    s_mov_b32 m0, s62
    s_nop 0
    buffer_load_dwordx4 v16, s[16:19], s26 offen offset:0 nt lds
    buffer_load_dwordx4 v17, s[16:19], s26 offen offset:1024 nt lds
    buffer_load_dwordx4 v16, s[16:19], s26 offen offset:2048 nt lds
    buffer_load_dwordx4 v17, s[16:19], s26 offen offset:3072 nt lds
    s_mov_b32 m0, s63
    s_nop 0
    buffer_load_dwordx4 v16, s[16:19], s27 offen offset:0 nt lds
    buffer_load_dwordx4 v17, s[16:19], s27 offen offset:1024 nt lds
    buffer_load_dwordx4 v16, s[16:19], s27 offen offset:2048 nt lds
    buffer_load_dwordx4 v17, s[16:19], s27 offen offset:3072 nt lds
    s_waitcnt vmcnt(0)
    ds_read_b64_tr_b16 a[160:161], v24 offset:0
    ds_read_b64_tr_b16 a[162:163], v24 offset:4096
    ds_read_b64_tr_b16 a[164:165], v24 offset:8192
    ds_read_b64_tr_b16 a[166:167], v24 offset:12288
    ds_read_b64_tr_b16 a[168:169], v25 offset:0
    ds_read_b64_tr_b16 a[170:171], v25 offset:4096
    ds_read_b64_tr_b16 a[172:173], v25 offset:8192
    ds_read_b64_tr_b16 a[174:175], v25 offset:12288
    ds_read_b64_tr_b16 a[176:177], v26 offset:0
    ds_read_b64_tr_b16 a[178:179], v26 offset:4096
    ds_read_b64_tr_b16 a[180:181], v26 offset:8192
    ds_read_b64_tr_b16 a[182:183], v26 offset:12288
    ds_read_b64_tr_b16 a[184:185], v27 offset:0
    ds_read_b64_tr_b16 a[186:187], v27 offset:4096
    ds_read_b64_tr_b16 a[188:189], v27 offset:8192
    ds_read_b64_tr_b16 a[190:191], v27 offset:12288
    s_waitcnt lgkmcnt(0)
    v_mfma_f32_16x16x32_bf16 v[224:227], a[96:99], a[48:51], 0
    v_mfma_f32_16x16x32_bf16 v[224:227], a[100:103], a[52:55], v[224:227]
    v_mfma_f32_16x16x32_bf16 v[224:227], a[104:107], a[56:59], v[224:227]
    v_mfma_f32_16x16x32_bf16 v[224:227], a[108:111], a[60:63], v[224:227]
    v_mfma_f32_16x16x32_bf16 v[228:231], a[112:115], a[48:51], 0
    v_mfma_f32_16x16x32_bf16 v[228:231], a[116:119], a[52:55], v[228:231]
    v_mfma_f32_16x16x32_bf16 v[228:231], a[120:123], a[56:59], v[228:231]
    v_mfma_f32_16x16x32_bf16 v[228:231], a[124:127], a[60:63], v[228:231]
    v_mfma_f32_16x16x32_bf16 v[232:235], a[128:131], a[48:51], 0
    v_mfma_f32_16x16x32_bf16 v[232:235], a[132:135], a[52:55], v[232:235]
    v_mfma_f32_16x16x32_bf16 v[232:235], a[136:139], a[56:59], v[232:235]
    v_mfma_f32_16x16x32_bf16 v[232:235], a[140:143], a[60:63], v[232:235]
    v_mfma_f32_16x16x32_bf16 v[236:239], a[144:147], a[48:51], 0
    v_mfma_f32_16x16x32_bf16 v[236:239], a[148:151], a[52:55], v[236:239]
    v_mfma_f32_16x16x32_bf16 v[236:239], a[152:155], a[56:59], v[236:239]
    v_mfma_f32_16x16x32_bf16 v[236:239], a[156:159], a[60:63], v[236:239]
    s_nop 9
    v_sub_f32 v224, v224, v248
    v_sub_f32 v225, v225, v248
    v_sub_f32 v226, v226, v248
    v_sub_f32 v227, v227, v248
    v_sub_f32 v228, v228, v248
    v_sub_f32 v229, v229, v248
    v_sub_f32 v230, v230, v248
    v_sub_f32 v231, v231, v248
    v_sub_f32 v232, v232, v248
    v_sub_f32 v233, v233, v248
    v_sub_f32 v234, v234, v248
    v_sub_f32 v235, v235, v248
    v_sub_f32 v236, v236, v248
    v_sub_f32 v237, v237, v248
    v_sub_f32 v238, v238, v248
    v_sub_f32 v239, v239, v248
    v_exp_f32 v224, v224
    v_exp_f32 v225, v225
    v_exp_f32 v226, v226
    v_exp_f32 v227, v227
    v_exp_f32 v228, v228
    v_exp_f32 v229, v229
    v_exp_f32 v230, v230
    v_exp_f32 v231, v231
    v_exp_f32 v232, v232
    v_exp_f32 v233, v233
    v_exp_f32 v234, v234
    v_exp_f32 v235, v235
    v_exp_f32 v236, v236
    v_exp_f32 v237, v237
    v_exp_f32 v238, v238
    v_exp_f32 v239, v239
    s_nop 0
    v_cvt_pk_bf16_f32 v240, v224, v225
    v_cvt_pk_bf16_f32 v241, v226, v227
    v_cvt_pk_bf16_f32 v242, v228, v229
    v_cvt_pk_bf16_f32 v243, v230, v231
    v_cvt_pk_bf16_f32 v244, v232, v233
    v_cvt_pk_bf16_f32 v245, v234, v235
    v_cvt_pk_bf16_f32 v246, v236, v237
    v_cvt_pk_bf16_f32 v247, v238, v239
    s_nop 1
    v_mfma_f32_16x16x32_bf16 a[236:239], a[248:251], v[240:243], a[236:239]
    v_mfma_f32_16x16x32_bf16 a[236:239], a[248:251], v[244:247], a[236:239]
    v_mfma_f32_16x16x32_bf16 v[128:131], a[160:163], v[240:243], v[128:131]
    v_mfma_f32_16x16x32_bf16 v[128:131], a[164:167], v[244:247], v[128:131]
    v_mfma_f32_16x16x32_bf16 v[132:135], a[168:171], v[240:243], v[132:135]
    v_mfma_f32_16x16x32_bf16 v[132:135], a[172:175], v[244:247], v[132:135]
    v_mfma_f32_16x16x32_bf16 v[136:139], a[176:179], v[240:243], v[136:139]
    v_mfma_f32_16x16x32_bf16 v[136:139], a[180:183], v[244:247], v[136:139]
    v_mfma_f32_16x16x32_bf16 v[140:143], a[184:187], v[240:243], v[140:143]
    v_mfma_f32_16x16x32_bf16 v[140:143], a[188:191], v[244:247], v[140:143]
    v_mfma_f32_16x16x32_bf16 v[224:227], a[96:99], a[64:67], 0
    v_mfma_f32_16x16x32_bf16 v[224:227], a[100:103], a[68:71], v[224:227]
    v_mfma_f32_16x16x32_bf16 v[224:227], a[104:107], a[72:75], v[224:227]
    v_mfma_f32_16x16x32_bf16 v[224:227], a[108:111], a[76:79], v[224:227]
    v_mfma_f32_16x16x32_bf16 v[228:231], a[112:115], a[64:67], 0
    v_mfma_f32_16x16x32_bf16 v[228:231], a[116:119], a[68:71], v[228:231]
    v_mfma_f32_16x16x32_bf16 v[228:231], a[120:123], a[72:75], v[228:231]
    v_mfma_f32_16x16x32_bf16 v[228:231], a[124:127], a[76:79], v[228:231]
    v_mfma_f32_16x16x32_bf16 v[232:235], a[128:131], a[64:67], 0
    v_mfma_f32_16x16x32_bf16 v[232:235], a[132:135], a[68:71], v[232:235]
    v_mfma_f32_16x16x32_bf16 v[232:235], a[136:139], a[72:75], v[232:235]
    v_mfma_f32_16x16x32_bf16 v[232:235], a[140:143], a[76:79], v[232:235]
    v_mfma_f32_16x16x32_bf16 v[236:239], a[144:147], a[64:67], 0
    v_mfma_f32_16x16x32_bf16 v[236:239], a[148:151], a[68:71], v[236:239]
    v_mfma_f32_16x16x32_bf16 v[236:239], a[152:155], a[72:75], v[236:239]
    v_mfma_f32_16x16x32_bf16 v[236:239], a[156:159], a[76:79], v[236:239]
    s_nop 9
    v_sub_f32 v224, v224, v249
    v_sub_f32 v225, v225, v249
    v_sub_f32 v226, v226, v249
    v_sub_f32 v227, v227, v249
    v_sub_f32 v228, v228, v249
    v_sub_f32 v229, v229, v249
    v_sub_f32 v230, v230, v249
    v_sub_f32 v231, v231, v249
    v_sub_f32 v232, v232, v249
    v_sub_f32 v233, v233, v249
    v_sub_f32 v234, v234, v249
    v_sub_f32 v235, v235, v249
    v_sub_f32 v236, v236, v249
    v_sub_f32 v237, v237, v249
    v_sub_f32 v238, v238, v249
    v_sub_f32 v239, v239, v249
    v_exp_f32 v224, v224
    v_exp_f32 v225, v225
    v_exp_f32 v226, v226
    v_exp_f32 v227, v227
    v_exp_f32 v228, v228
    v_exp_f32 v229, v229
    v_exp_f32 v230, v230
    v_exp_f32 v231, v231
    v_exp_f32 v232, v232
    v_exp_f32 v233, v233
    v_exp_f32 v234, v234
    v_exp_f32 v235, v235
    v_exp_f32 v236, v236
    v_exp_f32 v237, v237
    v_exp_f32 v238, v238
    v_exp_f32 v239, v239
    s_nop 0
    v_cvt_pk_bf16_f32 v240, v224, v225
    v_cvt_pk_bf16_f32 v241, v226, v227
    v_cvt_pk_bf16_f32 v242, v228, v229
    v_cvt_pk_bf16_f32 v243, v230, v231
    v_cvt_pk_bf16_f32 v244, v232, v233
    v_cvt_pk_bf16_f32 v245, v234, v235
    v_cvt_pk_bf16_f32 v246, v236, v237
    v_cvt_pk_bf16_f32 v247, v238, v239
    s_nop 1
    v_mfma_f32_16x16x32_bf16 a[240:243], a[248:251], v[240:243], a[240:243]
    v_mfma_f32_16x16x32_bf16 a[240:243], a[248:251], v[244:247], a[240:243]
    v_mfma_f32_16x16x32_bf16 v[160:163], a[160:163], v[240:243], v[160:163]
    v_mfma_f32_16x16x32_bf16 v[160:163], a[164:167], v[244:247], v[160:163]
    v_mfma_f32_16x16x32_bf16 v[164:167], a[168:171], v[240:243], v[164:167]
    v_mfma_f32_16x16x32_bf16 v[164:167], a[172:175], v[244:247], v[164:167]
    v_mfma_f32_16x16x32_bf16 v[168:171], a[176:179], v[240:243], v[168:171]
    v_mfma_f32_16x16x32_bf16 v[168:171], a[180:183], v[244:247], v[168:171]
    v_mfma_f32_16x16x32_bf16 v[172:175], a[184:187], v[240:243], v[172:175]
    v_mfma_f32_16x16x32_bf16 v[172:175], a[188:191], v[244:247], v[172:175]
    v_mfma_f32_16x16x32_bf16 v[224:227], a[96:99], a[80:83], 0
    v_mfma_f32_16x16x32_bf16 v[224:227], a[100:103], a[84:87], v[224:227]
    v_mfma_f32_16x16x32_bf16 v[224:227], a[104:107], a[88:91], v[224:227]
    v_mfma_f32_16x16x32_bf16 v[224:227], a[108:111], a[92:95], v[224:227]
    v_mfma_f32_16x16x32_bf16 v[228:231], a[112:115], a[80:83], 0
    v_mfma_f32_16x16x32_bf16 v[228:231], a[116:119], a[84:87], v[228:231]
    v_mfma_f32_16x16x32_bf16 v[228:231], a[120:123], a[88:91], v[228:231]
    v_mfma_f32_16x16x32_bf16 v[228:231], a[124:127], a[92:95], v[228:231]
    v_mfma_f32_16x16x32_bf16 v[232:235], a[128:131], a[80:83], 0
    v_mfma_f32_16x16x32_bf16 v[232:235], a[132:135], a[84:87], v[232:235]
    v_mfma_f32_16x16x32_bf16 v[232:235], a[136:139], a[88:91], v[232:235]
    v_mfma_f32_16x16x32_bf16 v[232:235], a[140:143], a[92:95], v[232:235]
    v_mfma_f32_16x16x32_bf16 v[236:239], a[144:147], a[80:83], 0
    v_mfma_f32_16x16x32_bf16 v[236:239], a[148:151], a[84:87], v[236:239]
    v_mfma_f32_16x16x32_bf16 v[236:239], a[152:155], a[88:91], v[236:239]
    v_mfma_f32_16x16x32_bf16 v[236:239], a[156:159], a[92:95], v[236:239]
    s_nop 9
    v_sub_f32 v224, v224, v250
    v_sub_f32 v225, v225, v250
    v_sub_f32 v226, v226, v250
    v_sub_f32 v227, v227, v250
    v_sub_f32 v228, v228, v250
    v_sub_f32 v229, v229, v250
    v_sub_f32 v230, v230, v250
    v_sub_f32 v231, v231, v250
    v_sub_f32 v232, v232, v250
    v_sub_f32 v233, v233, v250
    v_sub_f32 v234, v234, v250
    v_sub_f32 v235, v235, v250
    v_sub_f32 v236, v236, v250
    v_sub_f32 v237, v237, v250
    v_sub_f32 v238, v238, v250
    v_sub_f32 v239, v239, v250
    v_exp_f32 v224, v224
    v_exp_f32 v225, v225
    v_exp_f32 v226, v226
    v_exp_f32 v227, v227
    v_exp_f32 v228, v228
    v_exp_f32 v229, v229
    v_exp_f32 v230, v230
    v_exp_f32 v231, v231
    v_exp_f32 v232, v232
    v_exp_f32 v233, v233
    v_exp_f32 v234, v234
    v_exp_f32 v235, v235
    v_exp_f32 v236, v236
    v_exp_f32 v237, v237
    v_exp_f32 v238, v238
    v_exp_f32 v239, v239
    s_nop 0
    v_cvt_pk_bf16_f32 v240, v224, v225
    v_cvt_pk_bf16_f32 v241, v226, v227
    v_cvt_pk_bf16_f32 v242, v228, v229
    v_cvt_pk_bf16_f32 v243, v230, v231
    v_cvt_pk_bf16_f32 v244, v232, v233
    v_cvt_pk_bf16_f32 v245, v234, v235
    v_cvt_pk_bf16_f32 v246, v236, v237
    v_cvt_pk_bf16_f32 v247, v238, v239
    s_nop 1
    v_mfma_f32_16x16x32_bf16 a[244:247], a[248:251], v[240:243], a[244:247]
    v_mfma_f32_16x16x32_bf16 a[244:247], a[248:251], v[244:247], a[244:247]
    v_mfma_f32_16x16x32_bf16 v[192:195], a[160:163], v[240:243], v[192:195]
    v_mfma_f32_16x16x32_bf16 v[192:195], a[164:167], v[244:247], v[192:195]
    v_mfma_f32_16x16x32_bf16 v[196:199], a[168:171], v[240:243], v[196:199]
    v_mfma_f32_16x16x32_bf16 v[196:199], a[172:175], v[244:247], v[196:199]
    v_mfma_f32_16x16x32_bf16 v[200:203], a[176:179], v[240:243], v[200:203]
    v_mfma_f32_16x16x32_bf16 v[200:203], a[180:183], v[244:247], v[200:203]
    v_mfma_f32_16x16x32_bf16 v[204:207], a[184:187], v[240:243], v[204:207]
    v_mfma_f32_16x16x32_bf16 v[204:207], a[188:191], v[244:247], v[204:207]
    s_add_u32 s24, s24, 16384
    s_add_u32 s25, s25, 16384
    s_add_u32 s26, s26, 16384
    s_add_u32 s27, s27, 16384
    s_add_u32 s38, s38, 1
    s_cmp_lt_u32 s38, 32
    s_cbranch_scc1 L_fb2
    s_nop 9
    v_accvgpr_read_b32 v10, a236
    s_nop 0
    v_rcp_f32 v10, v10
    s_nop 0
    v_mul_f32 v128, v128, v10
    v_mul_f32 v129, v129, v10
    v_mul_f32 v130, v130, v10
    v_mul_f32 v131, v131, v10
    v_mul_f32 v132, v132, v10
    v_mul_f32 v133, v133, v10
    v_mul_f32 v134, v134, v10
    v_mul_f32 v135, v135, v10
    v_cvt_pk_bf16_f32 v128, v128, v129
    v_cvt_pk_bf16_f32 v129, v130, v131
    v_cvt_pk_bf16_f32 v130, v132, v133
    v_cvt_pk_bf16_f32 v131, v134, v135
    s_mov_b32 s51, 0
    v_permlane16_swap_b32 v128, v130
    v_permlane16_swap_b32 v129, v131
    buffer_store_dwordx4 v[128:131], v8, s[20:23], s51 offen offset:0 sc0 sc1 nt
    v_mul_f32 v136, v136, v10
    v_mul_f32 v137, v137, v10
    v_mul_f32 v138, v138, v10
    v_mul_f32 v139, v139, v10
    v_mul_f32 v140, v140, v10
    v_mul_f32 v141, v141, v10
    v_mul_f32 v142, v142, v10
    v_mul_f32 v143, v143, v10
    v_cvt_pk_bf16_f32 v136, v136, v137
    v_cvt_pk_bf16_f32 v137, v138, v139
    v_cvt_pk_bf16_f32 v138, v140, v141
    v_cvt_pk_bf16_f32 v139, v142, v143
    s_mov_b32 s51, 0
    v_permlane16_swap_b32 v136, v138
    v_permlane16_swap_b32 v137, v139
    buffer_store_dwordx4 v[136:139], v8, s[20:23], s51 offen offset:64 sc0 sc1 nt
    v_accvgpr_read_b32 v10, a240
    s_nop 0
    v_rcp_f32 v10, v10
    s_nop 0
    v_mul_f32 v160, v160, v10
    v_mul_f32 v161, v161, v10
    v_mul_f32 v162, v162, v10
    v_mul_f32 v163, v163, v10
    v_mul_f32 v164, v164, v10
    v_mul_f32 v165, v165, v10
    v_mul_f32 v166, v166, v10
    v_mul_f32 v167, v167, v10
    v_cvt_pk_bf16_f32 v160, v160, v161
    v_cvt_pk_bf16_f32 v161, v162, v163
    v_cvt_pk_bf16_f32 v162, v164, v165
    v_cvt_pk_bf16_f32 v163, v166, v167
    s_mov_b32 s51, 4096
    v_permlane16_swap_b32 v160, v162
    v_permlane16_swap_b32 v161, v163
    buffer_store_dwordx4 v[160:163], v8, s[20:23], s51 offen offset:0 sc0 sc1 nt
    v_mul_f32 v168, v168, v10
    v_mul_f32 v169, v169, v10
    v_mul_f32 v170, v170, v10
    v_mul_f32 v171, v171, v10
    v_mul_f32 v172, v172, v10
    v_mul_f32 v173, v173, v10
    v_mul_f32 v174, v174, v10
    v_mul_f32 v175, v175, v10
    v_cvt_pk_bf16_f32 v168, v168, v169
    v_cvt_pk_bf16_f32 v169, v170, v171
    v_cvt_pk_bf16_f32 v170, v172, v173
    v_cvt_pk_bf16_f32 v171, v174, v175
    s_mov_b32 s51, 4096
    v_permlane16_swap_b32 v168, v170
    v_permlane16_swap_b32 v169, v171
    buffer_store_dwordx4 v[168:171], v8, s[20:23], s51 offen offset:64 sc0 sc1 nt
    v_accvgpr_read_b32 v10, a244
    s_nop 0
    v_rcp_f32 v10, v10
    s_nop 0
    v_mul_f32 v192, v192, v10
    v_mul_f32 v193, v193, v10
    v_mul_f32 v194, v194, v10
    v_mul_f32 v195, v195, v10
    v_mul_f32 v196, v196, v10
    v_mul_f32 v197, v197, v10
    v_mul_f32 v198, v198, v10
    v_mul_f32 v199, v199, v10
    v_cvt_pk_bf16_f32 v192, v192, v193
    v_cvt_pk_bf16_f32 v193, v194, v195
    v_cvt_pk_bf16_f32 v194, v196, v197
    v_cvt_pk_bf16_f32 v195, v198, v199
    s_mov_b32 s51, 8192
    v_permlane16_swap_b32 v192, v194
    v_permlane16_swap_b32 v193, v195
    buffer_store_dwordx4 v[192:195], v8, s[20:23], s51 offen offset:0 sc0 sc1 nt
    v_mul_f32 v200, v200, v10
    v_mul_f32 v201, v201, v10
    v_mul_f32 v202, v202, v10
    v_mul_f32 v203, v203, v10
    v_mul_f32 v204, v204, v10
    v_mul_f32 v205, v205, v10
    v_mul_f32 v206, v206, v10
    v_mul_f32 v207, v207, v10
    v_cvt_pk_bf16_f32 v200, v200, v201
    v_cvt_pk_bf16_f32 v201, v202, v203
    v_cvt_pk_bf16_f32 v202, v204, v205
    v_cvt_pk_bf16_f32 v203, v206, v207
    s_mov_b32 s51, 8192
    v_permlane16_swap_b32 v200, v202
    v_permlane16_swap_b32 v201, v203
    buffer_store_dwordx4 v[200:203], v8, s[20:23], s51 offen offset:64 sc0 sc1 nt
    s_branch L_fin
s_endpgm
.section .rodata,"a"
.p2align 6
.amdhsa_kernel standalone__gqa_softmax__near_ridge_kernel
  .amdhsa_next_free_vgpr 512
  .amdhsa_next_free_sgpr 96
  .amdhsa_accum_offset 256
  .amdhsa_group_segment_fixed_size 0
  .amdhsa_kernarg_size 48
  .amdhsa_user_sgpr_count 2
  .amdhsa_user_sgpr_kernarg_segment_ptr 1
  .amdhsa_system_sgpr_workgroup_id_x 1
  .amdhsa_float_denorm_mode_32 3
.end_amdhsa_kernel
```
